```python
import torch

def _softmax(x, axis=-1):
    return torch.softmax(x, dim=axis)
def _gelu(x):
    return torch.nn.functional.gelu(x, approximate="tanh")
def _silu(x):
    return torch.nn.functional.silu(x)
def _sigmoid(x):
    return torch.sigmoid(x)
def _layernorm(x, axis=-1, eps=1e-5):
    m = x.mean(dim=axis, keepdim=True)
    v = x.var(dim=axis, keepdim=True, unbiased=False)
    return (x - m) / torch.sqrt(v + eps)
def _scatter_add(tgt, idx, src, axis=0):
    return tgt.clone().index_add_(axis, idx, src)
def _segment_sum(src, seg, n):
    out = torch.zeros((n,) + src.shape[1:], dtype=src.dtype)
    return out.index_add_(0, seg, src)
def _pad(x, pw):
    flat = tuple(v for pair in reversed(pw) for v in pair)
    return torch.nn.functional.pad(x, flat)

kernel_name = 'interleave_layers__ssm_conv_h3__linear_attn_block__prompt'

def setup_inputs():

    _w = (lambda a: (lambda t: t.to(torch.bfloat16) if t.is_floating_point() else t)(torch.as_tensor(a)))
    def _A_setup():
        B, S, D = 1, 2048, 512
        ks = 4
        return {
            "q": _w((lambda *s: torch.randn(*s, dtype=torch.bfloat16) * 0.05)(B, S, D)),
            "k": _w((lambda *s: torch.randn(*s, dtype=torch.bfloat16) * 0.4)(B, S, D)),
            "v": _w((lambda *s: torch.randn(*s, dtype=torch.bfloat16) * 0.4)(B, S, D)),
            "shift_k": _w((lambda *s: torch.randn(*s, dtype=torch.bfloat16) * 0.4)(D, ks) * 0.5),
            "ssm_k": _w((lambda *s: torch.randn(*s, dtype=torch.bfloat16) * 0.4)(D, S) * (1.0 / S ** 0.5)),
            "ssm_D": _w((lambda *s: torch.randn(*s, dtype=torch.bfloat16) * 0.4)(D)),
        }
    _A_in = _A_setup()

    def _B_setup():
        B, S, D = 1, 2048, 512
        return {
            "x": _w((lambda *s: torch.randn(*s, dtype=torch.bfloat16) * 0.05)(B, S, D)),
            "wqkv": _w((lambda *s: torch.randn(*s, dtype=torch.bfloat16) * 0.1)(D, 3 * D)),
            "wo": _w((lambda *s: torch.randn(*s, dtype=torch.bfloat16) * 0.05)(D, D)),
        }
    _B_in = _B_setup()

    return {
        "A_q": _A_in["q"],
        "A_k": _A_in["k"],
        "A_v": _A_in["v"],
        "A_shift_k": _A_in["shift_k"],
        "A_ssm_k": _A_in["ssm_k"],
        "A_ssm_D": _A_in["ssm_D"],
        "B_x": _B_in["x"],
        "B_wqkv": _B_in["wqkv"],
        "B_wo": _B_in["wo"],
    }

def reference(A_q, A_k, A_v, A_shift_k, A_ssm_k, A_ssm_D, B_x, B_wqkv, B_wo):
    def _A_ref(q, k, v, shift_k, ssm_k, ssm_D):
        B, S, D = q.shape
        ks = shift_k.shape[-1]
        k_pad = _pad(k, ((0, 0), (ks - 1, 0), (0, 0)))
        k_shift = torch.zeros_like(k)
        for t in range(ks):
            k_shift = k_shift + k_pad[:, t:t + S, :] * shift_k[:, ks - 1 - t][None, None, :]
        kv = k_shift * v
        L = 2 * S
        kv_pad = _pad(kv, ((0, 0), (0, S), (0, 0)))
        kf_pad = _pad(ssm_k, ((0, 0), (0, S)))
        kv_f = (lambda x, axes=(-2,-1): torch.fft.rfft2(x.float(), dim=axes))(kv_pad[:, None, :, :], axes=(1, 2))
        kf_f = (lambda x, axes=(-2,-1): torch.fft.rfft2(x.float(), dim=axes))(kf_pad[:, None, :], axes=(1, 2))
        kf_f = (lambda x, *d: x.permute(*d))(kf_f, 1, 2, 0)
        y_f = kv_f * kf_f[None, :, :, :]
        y = (lambda x, s, axes=(-2,-1): torch.fft.irfft2(x, s=s, dim=axes).to(torch.bfloat16))(y_f, (1, L), axes=(1, 2))[:, 0, :S, :]
        y = y + kv * ssm_D[None, None, :]
        return q * y

    def _B_ref(x, wqkv, wo):
        B, S, D = x.shape
        H = 32; Dh = D // H
        qkv = (lambda x, *d: x.permute(*d))((x @ wqkv).reshape(B, S, 3, H, Dh), 2, 0, 3, 1, 4)
        q, k, v = qkv[0], qkv[1], qkv[2]
        phi = lambda t: torch.where(t > 0, t + 1, torch.exp(t)) + 1e-6
        pq, pk = phi(q), phi(k)
        kv = torch.einsum("bhsd,bhse->bhde", pk, v)
        z = torch.einsum("bhsd->bhd", pk)
        num = torch.einsum("bhqd,bhde->bhqe", pq, kv)
        den = torch.einsum("bhqd,bhd->bhq", pq, z)[..., None] + 1e-6
        o = num / den
        return (lambda x, *d: x.permute(*d))(o, 0, 2, 1, 3).reshape(B, S, D) @ wo

    x = A_q
    x = x + _A_ref(_layernorm(x, axis=-1), A_k, A_v, A_shift_k, A_ssm_k, A_ssm_D)
    x = x + _B_ref(_layernorm(x, axis=-1), B_wqkv, B_wo)
    x = x + _A_ref(_layernorm(x, axis=-1), A_k, A_v, A_shift_k, A_ssm_k, A_ssm_D)
    x = x + _B_ref(_layernorm(x, axis=-1), B_wqkv, B_wo)
    return x
```

```asm
; @launch grid=(256,1,1) block=(256,1,1) lds=163840
.amdgcn_target "amdgcn-amd-amdhsa--gfx950"
.text
.globl interleave_layers__ssm_conv_h3__linear_attn_block__prompt_kernel
.p2align 8
.type interleave_layers__ssm_conv_h3__linear_attn_block__prompt_kernel,@function
interleave_layers__ssm_conv_h3__linear_attn_block__prompt_kernel:
    s_cmp_ge_u32 s2, 256
    s_cbranch_scc1 L_end
    s_load_dwordx16 s[64:79], s[0:1], 0
    s_load_dwordx8 s[80:87], s[0:1], 64
    s_lshr_b32 s45, s2, 3
    s_and_b32 s44, s2, 7
    v_and_b32 v5, 7, v0
    v_lshrrev_b32 v6, 3, v0
    s_lshl_b32 s58, s45, 16
    s_lshl_b32 s59, s44, 7
    s_add_u32 s58, s58, s59
    v_lshlrev_b32 v6, 11, v6
    v_lshl_add_u32 v6, v5, 4, v6
    v_add_u32 v76, s58, v6
    s_getpc_b64 s[62:63]
L_pc:
    s_lshl_b32 s58, s45, 10
    v_lshl_add_u32 v4, v5, 7, s58
    v_min_u32 v4, L_last-L_pc-4, v4
    global_load_dword v84, v4, s[62:63]
    s_waitcnt lgkmcnt(0)
    global_load_dwordx4 v[20:23], v76, s[66:67]
    global_load_dwordx4 v[24:27], v76, s[66:67] offset:1024
    global_load_dwordx4 v[28:31], v76, s[68:69]
    global_load_dwordx4 v[32:35], v76, s[68:69] offset:1024
    s_mov_b32 s8, s66
    s_mov_b32 s9, s67
    s_mov_b32 s10, 0x200000
    s_mov_b32 s11, 0x20000
    v_add_u32 v77, 0xfffffc00, v76
    v_add_u32 v78, 0xfffff800, v76
    v_add_u32 v79, 0xfffff400, v76
    buffer_load_dwordx4 v[16:19], v77, s[8:11], 0 offen
    buffer_load_dwordx4 v[12:15], v78, s[8:11], 0 offen
    buffer_load_dwordx4 v[8:11], v79, s[8:11], 0 offen
    s_lshl_b32 s54, s44, 5
    s_add_u32 s54, s54, s45
    s_lshl_b32 s61, s54, 2
    s_load_dword s55, s[74:75], s61
    s_load_dword s48, s[86:87], 0
    v_lshrrev_b32 v4, 6, v0
    v_lshlrev_b32 v81, 4, v0
    v_readfirstlane_b32 s46, v4
    v_and_b32 v80, 31, v0
    v_lshlrev_b32 v80, 4, v80
    s_lshl_b32 s59, s44, 9
    s_mov_b32 s20, s70
    s_mov_b32 s21, s71
    s_mov_b32 s22, 4096
    s_mov_b32 s23, 0x20000
    s_lshl_b32 s60, s46, 10
    s_add_u32 s60, s60, 50688
    s_mov_b32 m0, s60
    s_mov_b32 s4, s86
    s_mov_b32 s5, s87
    s_mov_b32 s6, 17825792
    s_mov_b32 s7, 0x20000
    buffer_load_dwordx4 v80, s[20:23], s59 offen lds
    v_lshl_add_u32 v80, v5, 6, s60
    v_mov_b32 v2, 0x40000000
    v_cmp_eq_u32 vcc, 0, v0
    s_nop 1
    v_cndmask_b32 v87, v2, v0, vcc
    v_and_b32 v0, 63, v0
    v_lshlrev_b32 v1, 4, v0
    v_cmp_eq_u32 vcc, 0, v0
    s_lshr_b32 s50, s54, 2
    s_and_b32 s51, s45, 3
    v_cndmask_b32 v2, v2, v0, vcc
    s_lshr_b32 s52, s50, 2
    s_and_b32 s53, s45, 15
    s_mov_b32 s49, 0
    s_mov_b32 s36, s82
    s_mov_b32 s37, s83
    s_mov_b32 s38, 0x200000
    s_mov_b32 s39, 0x20000
    s_mov_b32 s24, s72
    s_mov_b32 s25, s73
    s_mov_b32 s26, 0x200000
    s_mov_b32 s27, 0x20000
    s_lshl_b32 s58, s54, 13
    buffer_load_dwordx4 v[52:55], v81, s[24:27], s58 offen
    buffer_load_dwordx2 v[56:57], v81, s[24:27], s58 offen offset:16
    s_add_u32 s58, s58, 4096
    buffer_load_dwordx4 v[58:61], v81, s[24:27], s58 offen
    buffer_load_dwordx2 v[62:63], v81, s[24:27], s58 offen offset:16
    v_add_u32 v81, 32, v81
    v_and_b32 v184, 15, v0
    v_lshlrev_b32 v83, 7, v184
    s_lshl_b32 s58, s54, 13
    s_lshl_b32 s59, s46, 11
    s_add_u32 s59, s59, s58
    buffer_load_dword v85, v83, s[36:39], s59 offen
    s_lshl_b32 s58, s46, 4
    v_add_u32 v184, s58, v184
    v_lshrrev_b32 v185, 2, v184
    v_and_b32 v186, 3, v184
    v_lshlrev_b32 v187, 17, v185
    s_lshl_b32 s59, s54, 9
    s_add_u32 s59, s59, 1048576
    v_add_u32 v187, s59, v187
    v_min_u32 v185, 10, v185
    v_lshlrev_b32 v185, 12, v185
    s_lshl_b32 s59, s44, 9
    s_add_u32 s59, s59, -4096
    v_add_u32 v185, s59, v185
    v_cmp_gt_u32 vcc, 8, v184
    s_nop 1
    v_cndmask_b32 v187, v185, v187, vcc
    v_lshl_add_u32 v187, v186, 7, v187
    buffer_load_dword v199, v187, s[4:7], 0 offen
    s_mov_b32 s16, s64
    s_mov_b32 s17, s65
    s_mov_b32 s18, 0x200000
    s_mov_b32 s19, 0x20000
    s_mov_b32 s28, s78
    s_mov_b32 s29, s79
    s_mov_b32 s30, 0x180000
    s_mov_b32 s31, 0x20000
    s_mov_b32 s32, s80
    s_mov_b32 s33, s81
    s_mov_b32 s34, 0x80000
    s_mov_b32 s35, 0x20000
    s_mov_b32 s88, 0x05040100
    s_mov_b32 s89, 0x07060302
    s_mov_b32 s90, 0xffff0000
    s_mov_b32 s91, 0x3f800008
    s_mov_b32 s92, 0x358637bd
    s_mov_b32 s93, 0x3b000000
    s_mov_b32 s94, 0x3727c5ac
    s_mov_b32 s95, 0x3fb8aa3b
    s_mov_b32 s96, 0x00003f80
    s_mov_b32 s97, 0x3f800000
    v_mov_b32 v100, 0x3f803f80
    v_mov_b32 v101, 0x3f803f80
    v_mov_b32 v102, 0x3f803f80
    v_mov_b32 v103, 0x3f803f80
    v_lshrrev_b32 v4, 4, v0
    v_and_b32 v5, 15, v0
    v_lshlrev_b32 v3, 10, v5
    v_lshl_add_u32 v3, v4, 4, v3
    s_lshl_b32 s58, s50, 15
    s_lshl_b32 s59, s51, 8
    s_add_u32 s58, s58, s59
    s_lshl_b32 s59, s46, 6
    s_add_u32 s58, s58, s59
    v_add_u32 v3, s58, v3
    s_getreg_b32 s77, hwreg(HW_REG_XCC_ID, 0, 4)
    v_lshlrev_b32 v64, 2, v4
    v_xor_b32 v86, v5, v64
    v_lshlrev_b32 v86, 4, v86
    v_lshl_add_u32 v86, v4, 10, v86
    v_lshrrev_b32 v64, 2, v0
    v_mul_u32_u24 v64, 3072, v64
    v_and_b32 v65, 2, v4
    v_and_b32 v66, 3, v0
    v_xor_b32 v65, v65, v66
    v_lshl_add_u32 v6, v65, 4, v64
    v_lshrrev_b32 v176, 3, v0
    v_and_b32 v177, 7, v0
    v_lshlrev_b32 v176, 8, v176
    v_lshl_add_u32 v176, v177, 4, v176
    s_lshl_b32 s58, s46, 11
    s_add_u32 s58, s58, 42496
    v_add_u32 v176, s58, v176
    v_and_b32 v178, 1, v4
    v_lshrrev_b32 v179, 1, v4
    v_bfe_u32 v180, v0, 2, 2
    v_lshl_add_u32 v180, v178, 3, v180
    v_sub_u32 v180, 11, v180
    v_lshlrev_b32 v180, 7, v180
    v_lshl_add_u32 v180, v179, 5, v180
    v_lshl_add_u32 v180, v66, 3, v180
    v_add_u32 v180, s58, v180
    v_lshrrev_b32 v182, 1, v5
    v_lshl_add_u32 v182, v179, 3, v182
    v_lshlrev_b32 v182, 13, v182
    v_and_b32 v181, 1, v5
    v_lshl_add_u32 v182, v181, 5, v182
    v_lshl_add_u32 v182, v178, 4, v182
    s_lshl_b32 s64, s44, 18
    s_lshl_b32 s59, s45, 8
    s_add_u32 s64, s64, s59
    s_lshl_b32 s59, s46, 6
    s_add_u32 s64, s64, s59
    s_add_u32 s64, s64, 0
    s_add_u32 s65, s64, 0x20000
    s_lshl_b32 s72, s45, 2
    s_add_u32 s72, s72, s46
    s_lshl_b32 s72, s72, 2
    s_lshl_b32 s71, s44, 9
    s_add_u32 s71, s71, 4096
    s_add_u32 s72, s72, s71
    v_lshrrev_b32 v64, 2, v5
    v_lshl_add_u32 v64, v178, 2, v64
    v_lshlrev_b32 v67, 16, v64
    v_and_b32 v64, 3, v5
    v_lshl_add_u32 v67, v64, 5, v67
    v_lshl_add_u32 v67, v179, 4, v67
    s_lshr_b32 s61, s46, 1
    s_lshl_b32 s40, s61, 20
    s_lshl_b32 s59, s54, 1
    s_and_b32 s58, s46, 1
    s_add_u32 s59, s59, s58
    s_lshl_b32 s59, s59, 7
    s_add_u32 s40, s40, s59
    s_add_u32 s40, s40, 2097152
    s_add_u32 s41, s40, 0x80000
    v_lshrrev_b32 v70, 1, v0
    v_sub_u32 v70, 31, v70
    v_lshlrev_b32 v70, 6, v70
    v_lshl_add_u32 v70, v181, 4, v70
    v_lshlrev_b32 v71, 3, v0
    v_add_u32 v68, 0x4000, v3
    s_lshl_b32 s66, s54, 13
    s_add_u32 s66, s66, 0
    s_and_b32 s59, s46, 1
    s_lshl_b32 s60, s59, 5
    s_add_u32 s66, s66, s60
    s_mul_i32 s68, s59, 4608
    s_lshr_b32 s60, s46, 1
    s_lshl_b32 s61, s60, 11
    s_add_u32 s68, s68, s61
    s_add_u32 s68, s68, 33280
    s_lshl_b32 s60, s60, 12
    s_sub_u32 s66, s66, s60
    s_add_u32 s66, s66, 6144
    s_sub_u32 s67, s66, 2048
    s_lshl_b32 s69, s45, 2
    s_lshl_b32 s58, s44, 9
    s_add_u32 s69, s69, s58
    s_add_u32 s69, s69, 24576
    v_add_u32 v64, 1, v5
    v_and_b32 v65, 3, v64
    v_lshrrev_b32 v64, 2, v64
    v_mul_u32_u24 v65, 4160, v65
    v_lshl_add_u32 v65, v64, 3, v65
    v_lshl_add_u32 v65, v4, 4, v65
    s_and_b32 s58, s46, 1
    s_lshr_b32 s61, s46, 1
    s_lshl_b32 s59, s61, 8
    s_mul_i32 s60, s58, 16640
    s_add_u32 s60, s60, s59
    v_add_u32 v72, s60, v65
    s_mul_i32 s58, s58, 4608
    s_add_u32 s60, s58, s59
    s_add_u32 s60, s60, 33760
    v_lshlrev_b32 v64, 5, v5
    v_lshlrev_b32 v65, 4, v4
    v_sub_u32 v65, v65, v64
    v_add_u32 v73, s60, v65
    v_lshl_add_u32 v65, v4, 3, v64
    s_lshl_b32 s60, s61, 11
    s_sub_u32 s60, s58, s60
    s_add_u32 s60, s60, 35832
    v_sub_u32 v74, s60, v65
    s_lshl_b32 s60, s46, 12
    s_add_u32 s59, s60, 49152
    v_add_u32 v75, s59, v1
    s_xor_b32 s60, s60, 8192
    s_add_u32 s59, s60, 49152
    v_add_u32 v69, s59, v1
    s_and_b32 s58, s53, 1
    s_and_b32 s59, s52, 1
    s_lshl_b32 s59, s59, 1
    s_add_u32 s58, s58, s59
    s_mul_i32 s59, s58, 2
    s_mul_i32 s60, s44, 1
    v_add_u32 v64, s60, v0
    v_mul_u32_u24 v65, 43, v64
    v_lshrrev_b32 v65, 8, v65
    v_mul_u32_u24 v65, 6, v65
    v_sub_u32 v64, v64, v65
    v_lshrrev_b32 v65, 1, v64
    v_and_b32 v64, 1, v64
    v_subrev_u32 v66, 6, v0
    v_mul_u32_u24 v78, 43, v66
    v_lshrrev_b32 v78, 8, v78
    v_mul_u32_u24 v79, 6, v78
    v_sub_u32 v66, v66, v79
    v_add_u32 v66, 2, v66
    v_cmp_gt_u32 vcc, 6, v0
    s_nop 0
    s_nop 0
    v_cndmask_b32 v64, v66, v64, vcc
    v_cndmask_b32 v65, v78, v65, vcc
    v_add_u32 v64, s59, v64
    v_and_b32 v64, 7, v64
    v_lshl_or_b32 v64, v65, 3, v64
    v_lshrrev_b32 v65, 3, v64
    v_and_b32 v64, 7, v64
    v_lshlrev_b32 v79, 15, v65
    v_lshl_add_u32 v79, v64, 10, v79
    v_add_u32 v79, 0x10000, v79
    v_mul_u32_u24 v78, 49152, v64
    v_add_u32 v64, 1, v65
    v_cmp_gt_u32 vcc, 2, v65
    v_lshlrev_b32 v64, 10, v64
    s_mul_i32 s58, s46, 393216
    s_lshl_b32 s59, s53, 6
    s_add_u32 s58, s58, s59
    v_cndmask_b32 v64, 0, v64, vcc
    v_add3_u32 v78, v78, v64, s58
    s_lshl_b32 s58, s46, 13
    v_add_u32 v79, s58, v79
    s_lshl_b32 s58, s53, 1
    s_and_b32 s59, s46, 1
    s_add_u32 s58, s58, s59
    s_lshl_b32 s58, s58, 4
    s_add_u32 s58, s58, s52
    s_lshl_b32 s59, s58, 9
    s_lshl_b32 s58, s58, 6
    s_add_u32 s58, s58, 261632
    v_add_u32 v192, s59, v1
    v_add_u32 v193, s58, v1
    v_cmp_gt_u32 vcc, 32, v0
    s_lshr_b32 s43, s46, 1
    s_mul_i32 s43, s43, 327680
    v_cndmask_b32 v192, v193, v192, vcc
    v_cmp_gt_u32 vcc, 36, v0
    v_mov_b32 v193, 0x40000000
    s_add_u32 s43, s43, 262144
    v_cndmask_b32 v192, v193, v192, vcc
    v_mov_b32 v188, -1
    v_mov_b32 v189, -1
    v_mov_b32 v190, -1
    v_mov_b32 v191, -1
    buffer_store_dwordx4 v[188:191], v67, s[4:7], s40 offen sc1
    buffer_store_dwordx4 v[188:191], v67, s[4:7], s41 offen sc1
    buffer_store_dwordx4 v[188:191], v192, s[4:7], s43 offen sc1
    s_waitcnt vmcnt(15)
    v_perm_b32 v131, v20, v24, s88
    v_perm_b32 v135, v20, v24, s89
    v_perm_b32 v139, v21, v25, s88
    v_perm_b32 v143, v21, v25, s89
    v_perm_b32 v147, v22, v26, s88
    v_perm_b32 v151, v22, v26, s89
    v_perm_b32 v155, v23, v27, s88
    v_perm_b32 v159, v23, v27, s89
    s_waitcnt vmcnt(14)
    v_lshlrev_b32 v112, 16, v28
    v_and_b32 v113, s90, v28
    v_lshlrev_b32 v114, 16, v29
    v_and_b32 v115, s90, v29
    v_lshlrev_b32 v116, 16, v30
    v_and_b32 v117, s90, v30
    v_lshlrev_b32 v118, 16, v31
    v_and_b32 v119, s90, v31
    s_waitcnt vmcnt(13)
    v_lshlrev_b32 v120, 16, v32
    v_and_b32 v121, s90, v32
    v_lshlrev_b32 v122, 16, v33
    v_and_b32 v123, s90, v33
    v_lshlrev_b32 v124, 16, v34
    v_and_b32 v125, s90, v34
    v_lshlrev_b32 v126, 16, v35
    v_and_b32 v127, s90, v35
    s_waitcnt vmcnt(9)
    ds_read_b128 v[36:39], v80 offset:0
    ds_read_b128 v[40:43], v80 offset:16
    ds_read_b128 v[44:47], v80 offset:32
    ds_read_b128 v[48:51], v80 offset:48
    v_perm_b32 v130, v16, v20, s88
    v_perm_b32 v134, v16, v20, s89
    v_perm_b32 v138, v17, v21, s88
    v_perm_b32 v142, v17, v21, s89
    v_perm_b32 v146, v18, v22, s88
    v_perm_b32 v150, v18, v22, s89
    v_perm_b32 v154, v19, v23, s88
    v_perm_b32 v158, v19, v23, s89
    v_perm_b32 v129, v12, v16, s88
    v_perm_b32 v133, v12, v16, s89
    v_perm_b32 v137, v13, v17, s88
    v_perm_b32 v141, v13, v17, s89
    v_perm_b32 v145, v14, v18, s88
    v_perm_b32 v149, v14, v18, s89
    v_perm_b32 v153, v15, v19, s88
    v_perm_b32 v157, v15, v19, s89
    v_perm_b32 v128, v8, v12, s88
    v_perm_b32 v132, v8, v12, s89
    v_perm_b32 v136, v9, v13, s88
    v_perm_b32 v140, v9, v13, s89
    v_perm_b32 v144, v10, v14, s88
    v_perm_b32 v148, v10, v14, s89
    v_perm_b32 v152, v11, v15, s88
    v_perm_b32 v156, v11, v15, s89
    s_waitcnt lgkmcnt(0)
    v_dot2_f32_bf16 v160, v130, v36, 0
    v_dot2_f32_bf16 v168, v131, v36, 0
    v_dot2_f32_bf16 v161, v134, v38, 0
    v_dot2_f32_bf16 v169, v135, v38, 0
    v_dot2_f32_bf16 v162, v138, v40, 0
    v_dot2_f32_bf16 v170, v139, v40, 0
    v_dot2_f32_bf16 v163, v142, v42, 0
    v_dot2_f32_bf16 v171, v143, v42, 0
    v_dot2_f32_bf16 v164, v146, v44, 0
    v_dot2_f32_bf16 v172, v147, v44, 0
    v_dot2_f32_bf16 v165, v150, v46, 0
    v_dot2_f32_bf16 v173, v151, v46, 0
    v_dot2_f32_bf16 v166, v154, v48, 0
    v_dot2_f32_bf16 v174, v155, v48, 0
    v_dot2_f32_bf16 v167, v158, v50, 0
    v_dot2_f32_bf16 v175, v159, v50, 0
    v_dot2_f32_bf16 v160, v128, v37, v160
    v_dot2_f32_bf16 v168, v129, v37, v168
    v_dot2_f32_bf16 v161, v132, v39, v161
    v_dot2_f32_bf16 v169, v133, v39, v169
    v_dot2_f32_bf16 v162, v136, v41, v162
    v_dot2_f32_bf16 v170, v137, v41, v170
    v_dot2_f32_bf16 v163, v140, v43, v163
    v_dot2_f32_bf16 v171, v141, v43, v171
    v_dot2_f32_bf16 v164, v144, v45, v164
    v_dot2_f32_bf16 v172, v145, v45, v172
    v_dot2_f32_bf16 v165, v148, v47, v165
    v_dot2_f32_bf16 v173, v149, v47, v173
    v_dot2_f32_bf16 v166, v152, v49, v166
    v_dot2_f32_bf16 v174, v153, v49, v174
    v_dot2_f32_bf16 v167, v156, v51, v167
    v_dot2_f32_bf16 v175, v157, v51, v175
    v_pk_mul_f32 v[160:161], v[160:161], v[112:113]
    v_pk_mul_f32 v[162:163], v[162:163], v[114:115]
    v_pk_mul_f32 v[164:165], v[164:165], v[116:117]
    v_pk_mul_f32 v[166:167], v[166:167], v[118:119]
    v_pk_mul_f32 v[168:169], v[168:169], v[120:121]
    v_pk_mul_f32 v[170:171], v[170:171], v[122:123]
    v_pk_mul_f32 v[172:173], v[172:173], v[124:125]
    v_pk_mul_f32 v[174:175], v[174:175], v[126:127]
    v_cvt_pk_bf16_f32 v144, v160, v161
    v_cvt_pk_bf16_f32 v145, v162, v163
    v_cvt_pk_bf16_f32 v146, v164, v165
    v_cvt_pk_bf16_f32 v147, v166, v167
    ds_write_b128 v176, v[144:147] offset:0
    v_cvt_pk_bf16_f32 v148, v168, v169
    v_cvt_pk_bf16_f32 v149, v170, v171
    v_cvt_pk_bf16_f32 v150, v172, v173
    v_cvt_pk_bf16_f32 v151, v174, v175
    ds_write_b128 v176, v[148:151] offset:128
    s_mul_i32 s48, s48, 0x9e3779b1
    s_add_u32 s48, s48, 0x7f4a7c15
    s_xor_b32 s47, s48, s77
    v_mov_b32 v99, s48
    v_mov_b32 v98, s47
    s_waitcnt lgkmcnt(0)
    ds_read_b64_tr_b16 v[128:129], v180 offset:512
    ds_read_b64_tr_b16 v[130:131], v180 offset:0
    ds_read_b64_tr_b16 v[132:133], v180 offset:576
    ds_read_b64_tr_b16 v[134:135], v180 offset:64
    s_waitcnt lgkmcnt(2)
    buffer_store_dwordx4 v[128:131], v182, s[36:39], s64 offen
    s_waitcnt lgkmcnt(0)
    buffer_store_dwordx4 v[132:135], v182, s[36:39], s65 offen
    s_waitcnt vmcnt(10)
    ds_write_b128 v81, v[52:55] offset:0
    v_alignbit_b32 v24, v53, v52, 16
    v_alignbit_b32 v25, v54, v53, 16
    v_alignbit_b32 v26, v55, v54, 16
    s_waitcnt vmcnt(9)
    v_alignbit_b32 v27, v56, v55, 16
    v_alignbit_b32 v28, v57, v56, 16
    ds_write_b128 v81, v[24:27] offset:4160
    v_mov_b32 v32, v53
    v_mov_b32 v33, v54
    v_mov_b32 v34, v55
    v_mov_b32 v35, v56
    ds_write_b128 v81, v[32:35] offset:8320
    v_mov_b32 v31, v28
    v_mov_b32 v28, v25
    v_mov_b32 v29, v26
    v_mov_b32 v30, v27
    ds_write_b128 v81, v[28:31] offset:12480
    s_waitcnt vmcnt(8)
    ds_write_b128 v81, v[58:61] offset:16640
    v_alignbit_b32 v24, v59, v58, 16
    v_alignbit_b32 v25, v60, v59, 16
    v_alignbit_b32 v26, v61, v60, 16
    s_waitcnt vmcnt(7)
    v_alignbit_b32 v27, v62, v61, 16
    v_alignbit_b32 v28, v63, v62, 16
    ds_write_b128 v81, v[24:27] offset:20800
    v_mov_b32 v32, v59
    v_mov_b32 v33, v60
    v_mov_b32 v34, v61
    v_mov_b32 v35, v62
    ds_write_b128 v81, v[32:35] offset:24960
    v_mov_b32 v31, v28
    v_mov_b32 v28, v25
    v_mov_b32 v29, v26
    v_mov_b32 v30, v27
    ds_write_b128 v81, v[28:31] offset:29120
    v_mov_b32 v32, 0
    v_mov_b32 v33, 0
    s_cmp_lg_u32 s46, 0
    s_cbranch_scc1 L_h1
    v_readfirstlane_b32 s58, v52
    v_readfirstlane_b32 s59, v53
    v_readfirstlane_b32 s60, v58
    v_readfirstlane_b32 s61, v59
    v_cmp_gt_u32 vcc, 8, v0
    v_mov_b32 v36, s60
    v_mov_b32 v37, s61
    v_mov_b32 v38, s58
    v_mov_b32 v39, s59
    v_cndmask_b32 v36, v36, v38, vcc
    v_cndmask_b32 v37, v37, v39, vcc
    v_bfe_u32 v38, v0, 1, 2
    v_lshlrev_b32 v39, 4, v38
    v_sub_u32 v39, 64, v39
    v_lshlrev_b64 v[34:35], v39, v[36:37]
    v_and_b32 v39, 1, v0
    v_mul_u32_u24 v40, v38, v39
    v_cmp_ne_u32 vcc, 0, v40
    v_mul_u32_u24 v38, 4160, v38
    v_lshl_add_u32 v38, v39, 4, v38
    v_bfe_u32 v39, v0, 3, 1
    v_cndmask_b32 v34, 0, v34, vcc
    v_cndmask_b32 v35, 0, v35, vcc
    v_mul_u32_u24 v39, 16640, v39
    v_add_u32 v38, v38, v39
    s_mov_b64 exec, 0xffff
    ds_write_b128 v38, v[32:35] offset:0
    s_mov_b64 exec, -1
L_h1:
    s_cmp_lg_u32 s46, 1
    s_cbranch_scc1 L_h2
    v_mov_b32 v34, 0
    v_mov_b32 v35, 0
    v_lshrrev_b32 v36, 5, v0
    v_and_b32 v37, 31, v0
    v_mul_u32_u24 v36, 4608, v36
    v_lshl_add_u32 v36, v37, 4, v36
    ds_write_b128 v36, v[32:35] offset:37376
L_h2:
    s_waitcnt vmcnt(0)
    s_cmp_lg_u32 s49, 0
    s_cbranch_scc1 L_ool3
L_back4:
    s_mov_b64 exec, 1
    buffer_store_dword v98, v2, s[4:7], s72 offen
    s_mov_b64 exec, -1
    s_and_b32 s56, s55, s90
    s_lshl_b32 s55, s55, 16
    s_bitcmp1_b32 s46, 0
    s_cselect_b32 s55, s56, s55
    s_cmp_eq_u32 s49, 0
    s_cselect_b32 s57, 600, 0
L_pl5:
    buffer_load_dwordx2 v[14:15], v71, s[4:7], s71 offen sc1
    s_sub_u32 s57, s57, 1
    s_waitcnt vmcnt(0)
    v_xor_b32 v14, s47, v14
    v_xor_b32 v15, s47, v15
    v_or_b32 v18, v14, v15
    v_cmp_ne_u32 vcc, 0, v18
    s_cbranch_scc1 L_ps7
    s_cbranch_vccnz L_pl5
L_pe8:
    s_mov_b32 m0, s68
    s_add_u32 s68, s68, 1024
    buffer_load_dwordx4 v70, s[36:39], s66 offen sc1 lds
    s_mov_b32 m0, s68
    s_nop 0
    buffer_load_dwordx4 v70, s[36:39], s67 offen sc1 lds
    s_lshl_b32 s58, s44, 7
    s_add_u32 s58, s58, 196608
    s_cmp_eq_u32 s45, 0
    s_cselect_b32 s58, s58, 0x40000000
    s_mov_b64 exec, 1
    buffer_store_dword v99, v87, s[4:7], s58 offen sc1
    s_mov_b64 exec, -1
    s_waitcnt vmcnt(1)
    s_waitcnt lgkmcnt(0)
    s_barrier
    ds_read_b64 a[0:1], v72 offset:0
    ds_read_b64 a[2:3], v72 offset:8
    ds_read_b128 a[60:63], v73 offset:0
    ds_read_b128 a[56:59], v73 offset:512
    ds_read_b128 a[52:55], v73 offset:1024
    ds_read_b128 a[48:51], v73 offset:1536
    ds_read_b128 a[44:47], v73 offset:2048
    ds_read_b128 a[40:43], v73 offset:2560
    ds_read_b128 a[36:39], v73 offset:3072
    ds_read_b128 a[32:35], v73 offset:3584
    s_waitcnt lgkmcnt(7)
    v_mfma_f32_16x16x32_bf16 v[36:39], a[0:3], a[60:63], 0
    s_waitcnt lgkmcnt(6)
    buffer_load_dwordx4 v[104:107], v3, s[16:19], 0 offen
    v_mfma_f32_16x16x32_bf16 v[32:35], a[0:3], a[56:59], 0
    s_waitcnt lgkmcnt(5)
    ds_read_b64 a[4:5], v72 offset:512
    v_mfma_f32_16x16x32_bf16 v[28:31], a[0:3], a[52:55], 0
    s_waitcnt lgkmcnt(5)
    ds_read_b64 a[6:7], v72 offset:520
    v_mfma_f32_16x16x32_bf16 v[24:27], a[0:3], a[48:51], 0
    s_waitcnt lgkmcnt(5)
    ds_read_b64 a[8:9], v72 offset:1024
    v_mfma_f32_16x16x32_bf16 v[20:23], a[0:3], a[44:47], 0
    s_waitcnt lgkmcnt(5)
    ds_read_b64 a[10:11], v72 offset:1032
    v_mfma_f32_16x16x32_bf16 v[16:19], a[0:3], a[40:43], 0
    s_waitcnt lgkmcnt(5)
    buffer_load_dwordx4 v[108:111], v68, s[16:19], 0 offen
    v_mfma_f32_16x16x32_bf16 v[12:15], a[0:3], a[36:39], 0
    s_waitcnt lgkmcnt(4)
    ds_read_b64 a[12:13], v72 offset:1536
    v_mfma_f32_16x16x32_bf16 v[8:11], a[0:3], a[32:35], 0
    s_waitcnt lgkmcnt(3)
    ds_read_b64 a[14:15], v72 offset:1544
    v_mfma_f32_16x16x32_bf16 v[36:39], a[4:7], a[56:59], v[36:39]
    ds_read_b64 a[16:17], v72 offset:2048
    v_mfma_f32_16x16x32_bf16 v[32:35], a[4:7], a[52:55], v[32:35]
    ds_read_b64 a[18:19], v72 offset:2056
    v_mfma_f32_16x16x32_bf16 v[28:31], a[4:7], a[48:51], v[28:31]
    ds_read_b64 a[20:21], v72 offset:2560
    v_readlane_b32 s76, v79, 0
    v_mfma_f32_16x16x32_bf16 v[24:27], a[4:7], a[44:47], v[24:27]
    ds_read_b64 a[22:23], v72 offset:2568
    v_readlane_b32 s73, v78, 0
    v_mfma_f32_16x16x32_bf16 v[20:23], a[4:7], a[40:43], v[20:23]
    s_mov_b32 m0, s76
    ds_read_b64 a[24:25], v72 offset:3072
    v_mfma_f32_16x16x32_bf16 v[16:19], a[4:7], a[36:39], v[16:19]
    s_nop 0
    buffer_load_dwordx4 v6, s[28:31], s73 offen lds
    v_mfma_f32_16x16x32_bf16 v[12:15], a[4:7], a[32:35], v[12:15]
    s_waitcnt lgkmcnt(7)
    ds_read_b64 a[26:27], v72 offset:3080
    v_mfma_f32_16x16x32_bf16 v[36:39], a[8:11], a[52:55], v[36:39]
    ds_read_b64 a[28:29], v72 offset:3584
    v_readlane_b32 s76, v79, 1
    v_mfma_f32_16x16x32_bf16 v[32:35], a[8:11], a[48:51], v[32:35]
    ds_read_b64 a[30:31], v72 offset:3592
    v_readlane_b32 s73, v78, 1
    v_mfma_f32_16x16x32_bf16 v[28:31], a[8:11], a[44:47], v[28:31]
    s_mov_b32 m0, s76
    ds_read_b64 a[64:65], v72 offset:64
    v_mfma_f32_16x16x32_bf16 v[24:27], a[8:11], a[40:43], v[24:27]
    s_nop 0
    buffer_load_dwordx4 v6, s[28:31], s73 offen lds
    v_mfma_f32_16x16x32_bf16 v[20:23], a[8:11], a[36:39], v[20:23]
    ds_read_b64 a[66:67], v72 offset:72
    v_mfma_f32_16x16x32_bf16 v[16:19], a[8:11], a[32:35], v[16:19]
    s_waitcnt lgkmcnt(10)
    ds_read_b128 a[124:127], v73 offset:64
    v_readlane_b32 s76, v79, 2
    v_mfma_f32_16x16x32_bf16 v[36:39], a[12:15], a[48:51], v[36:39]
    ds_read_b128 a[120:123], v73 offset:576
    v_readlane_b32 s73, v78, 2
    v_mfma_f32_16x16x32_bf16 v[32:35], a[12:15], a[44:47], v[32:35]
    s_mov_b32 m0, s76
    ds_read_b128 a[116:119], v73 offset:1088
    v_mfma_f32_16x16x32_bf16 v[28:31], a[12:15], a[40:43], v[28:31]
    s_nop 0
    buffer_load_dwordx4 v6, s[28:31], s73 offen lds
    v_mfma_f32_16x16x32_bf16 v[24:27], a[12:15], a[36:39], v[24:27]
    ds_read_b128 a[112:115], v73 offset:1600
    v_mfma_f32_16x16x32_bf16 v[20:23], a[12:15], a[32:35], v[20:23]
    s_waitcnt lgkmcnt(12)
    ds_read_b128 a[108:111], v73 offset:2112
    v_readlane_b32 s76, v79, 3
    v_mfma_f32_16x16x32_bf16 v[36:39], a[16:19], a[44:47], v[36:39]
    ds_read_b128 a[104:107], v73 offset:2624
    v_readlane_b32 s73, v78, 3
    v_mfma_f32_16x16x32_bf16 v[32:35], a[16:19], a[40:43], v[32:35]
    s_mov_b32 m0, s76
    ds_read_b128 a[100:103], v73 offset:3136
    v_mfma_f32_16x16x32_bf16 v[28:31], a[16:19], a[36:39], v[28:31]
    s_nop 0
    buffer_load_dwordx4 v6, s[28:31], s73 offen lds
    v_mfma_f32_16x16x32_bf16 v[24:27], a[16:19], a[32:35], v[24:27]
    s_waitcnt lgkmcnt(13)
    ds_read_b128 a[96:99], v73 offset:3648
    v_mfma_f32_16x16x32_bf16 v[36:39], a[20:23], a[40:43], v[36:39]
    ds_read_b64 a[68:69], v72 offset:576
    v_readlane_b32 s76, v79, 4
    v_mfma_f32_16x16x32_bf16 v[32:35], a[20:23], a[36:39], v[32:35]
    ds_read_b64 a[70:71], v72 offset:584
    v_readlane_b32 s73, v78, 4
    v_mfma_f32_16x16x32_bf16 v[28:31], a[20:23], a[32:35], v[28:31]
    s_waitcnt lgkmcnt(14)
    ds_read_b64 a[72:73], v72 offset:1088
    v_mfma_f32_16x16x32_bf16 v[36:39], a[24:27], a[36:39], v[36:39]
    s_mov_b32 m0, s76
    ds_read_b64 a[74:75], v72 offset:1096
    v_mfma_f32_16x16x32_bf16 v[32:35], a[24:27], a[32:35], v[32:35]
    s_waitcnt lgkmcnt(14)
    buffer_load_dwordx4 v6, s[28:31], s73 offen lds
    v_mfma_f32_16x16x32_bf16 v[36:39], a[28:31], a[32:35], v[36:39]
    s_waitcnt lgkmcnt(11)
    ds_read_b64 a[76:77], v72 offset:1600
    v_readlane_b32 s76, v79, 5
    v_mfma_f32_16x16x32_bf16 v[36:39], a[64:67], a[124:127], v[36:39]
    s_waitcnt lgkmcnt(11)
    ds_read_b64 a[78:79], v72 offset:1608
    v_readlane_b32 s73, v78, 5
    v_mfma_f32_16x16x32_bf16 v[32:35], a[64:67], a[120:123], v[32:35]
    s_waitcnt lgkmcnt(11)
    ds_read_b64 a[80:81], v72 offset:2112
    v_mfma_f32_16x16x32_bf16 v[28:31], a[64:67], a[116:119], v[28:31]
    s_waitcnt lgkmcnt(11)
    ds_read_b64 a[82:83], v72 offset:2120
    v_mfma_f32_16x16x32_bf16 v[24:27], a[64:67], a[112:115], v[24:27]
    s_waitcnt lgkmcnt(11)
    ds_read_b64 a[84:85], v72 offset:2624
    v_mfma_f32_16x16x32_bf16 v[20:23], a[64:67], a[108:111], v[20:23]
    s_waitcnt lgkmcnt(11)
    ds_read_b64 a[86:87], v72 offset:2632
    v_mfma_f32_16x16x32_bf16 v[16:19], a[64:67], a[104:107], v[16:19]
    s_waitcnt lgkmcnt(11)
    ds_read_b64 a[88:89], v72 offset:3136
    v_mfma_f32_16x16x32_bf16 v[12:15], a[64:67], a[100:103], v[12:15]
    s_waitcnt lgkmcnt(11)
    ds_read_b64 a[90:91], v72 offset:3144
    v_mfma_f32_16x16x32_bf16 v[8:11], a[64:67], a[96:99], v[8:11]
    s_waitcnt lgkmcnt(10)
    ds_read_b64 a[92:93], v72 offset:3648
    v_mfma_f32_16x16x32_bf16 v[36:39], a[68:71], a[120:123], v[36:39]
    s_mov_b32 m0, s76
    ds_read_b64 a[94:95], v72 offset:3656
    v_mfma_f32_16x16x32_bf16 v[32:35], a[68:71], a[116:119], v[32:35]
    buffer_load_dwordx4 v6, s[28:31], s73 offen lds
    v_mfma_f32_16x16x32_bf16 v[28:31], a[68:71], a[112:115], v[28:31]
    ds_read_b64 a[0:1], v72 offset:128
    v_mfma_f32_16x16x32_bf16 v[24:27], a[68:71], a[108:111], v[24:27]
    ds_read_b64 a[2:3], v72 offset:136
    v_mfma_f32_16x16x32_bf16 v[20:23], a[68:71], a[104:107], v[20:23]
    ds_read_b128 a[60:63], v73 offset:128
    v_mfma_f32_16x16x32_bf16 v[16:19], a[68:71], a[100:103], v[16:19]
    ds_read_b128 a[56:59], v73 offset:640
    v_mfma_f32_16x16x32_bf16 v[12:15], a[68:71], a[96:99], v[12:15]
    s_waitcnt lgkmcnt(14)
    ds_read_b128 a[52:55], v73 offset:1152
    v_mfma_f32_16x16x32_bf16 v[36:39], a[72:75], a[116:119], v[36:39]
    ds_read_b128 a[48:51], v73 offset:1664
    v_mfma_f32_16x16x32_bf16 v[32:35], a[72:75], a[112:115], v[32:35]
    ds_read_b128 a[44:47], v73 offset:2176
    v_mfma_f32_16x16x32_bf16 v[28:31], a[72:75], a[108:111], v[28:31]
    ds_read_b128 a[40:43], v73 offset:2688
    v_mfma_f32_16x16x32_bf16 v[24:27], a[72:75], a[104:107], v[24:27]
    ds_read_b128 a[36:39], v73 offset:3200
    v_mfma_f32_16x16x32_bf16 v[20:23], a[72:75], a[100:103], v[20:23]
    ds_read_b128 a[32:35], v73 offset:3712
    v_mfma_f32_16x16x32_bf16 v[16:19], a[72:75], a[96:99], v[16:19]
    s_waitcnt lgkmcnt(15)
    ds_read_b64 a[4:5], v72 offset:640
    v_mfma_f32_16x16x32_bf16 v[36:39], a[76:79], a[112:115], v[36:39]
    ds_read_b64 a[6:7], v72 offset:648
    v_mfma_f32_16x16x32_bf16 v[32:35], a[76:79], a[108:111], v[32:35]
    ds_read_b64 a[8:9], v72 offset:1152
    v_mfma_f32_16x16x32_bf16 v[28:31], a[76:79], a[104:107], v[28:31]
    ds_read_b64 a[10:11], v72 offset:1160
    v_mfma_f32_16x16x32_bf16 v[24:27], a[76:79], a[100:103], v[24:27]
    ds_read_b64 a[12:13], v72 offset:1664
    v_mfma_f32_16x16x32_bf16 v[20:23], a[76:79], a[96:99], v[20:23]
    ds_read_b64 a[14:15], v72 offset:1672
    v_mfma_f32_16x16x32_bf16 v[36:39], a[80:83], a[108:111], v[36:39]
    ds_read_b64 a[16:17], v72 offset:2176
    v_mfma_f32_16x16x32_bf16 v[32:35], a[80:83], a[104:107], v[32:35]
    ds_read_b64 a[18:19], v72 offset:2184
    v_mfma_f32_16x16x32_bf16 v[28:31], a[80:83], a[100:103], v[28:31]
    ds_read_b64 a[20:21], v72 offset:2688
    v_mfma_f32_16x16x32_bf16 v[24:27], a[80:83], a[96:99], v[24:27]
    s_waitcnt lgkmcnt(15)
    ds_read_b64 a[22:23], v72 offset:2696
    v_mfma_f32_16x16x32_bf16 v[36:39], a[84:87], a[104:107], v[36:39]
    ds_read_b64 a[24:25], v72 offset:3200
    v_mfma_f32_16x16x32_bf16 v[32:35], a[84:87], a[100:103], v[32:35]
    ds_read_b64 a[26:27], v72 offset:3208
    v_mfma_f32_16x16x32_bf16 v[28:31], a[84:87], a[96:99], v[28:31]
    ds_read_b64 a[28:29], v72 offset:3712
    v_mfma_f32_16x16x32_bf16 v[36:39], a[88:91], a[100:103], v[36:39]
    ds_read_b64 a[30:31], v72 offset:3720
    v_mfma_f32_16x16x32_bf16 v[32:35], a[88:91], a[96:99], v[32:35]
    ds_read_b64 v[56:57], v74 offset:1536
    v_mfma_f32_16x16x32_bf16 v[36:39], a[92:95], a[96:99], v[36:39]
    ds_read_b64 v[58:59], v74 offset:1024
    v_mfma_f32_16x16x32_bf16 v[36:39], a[0:3], a[60:63], v[36:39]
    ds_read_b64 a[64:65], v72 offset:192
    v_mfma_f32_16x16x32_bf16 v[32:35], a[0:3], a[56:59], v[32:35]
    s_waitcnt lgkmcnt(15)
    ds_read_b64 a[66:67], v72 offset:200
    v_mfma_f32_16x16x32_bf16 v[28:31], a[0:3], a[52:55], v[28:31]
    ds_read_b128 a[124:127], v73 offset:192
    v_mfma_f32_16x16x32_bf16 v[24:27], a[0:3], a[48:51], v[24:27]
    ds_read_b128 a[120:123], v73 offset:704
    v_mfma_f32_16x16x32_bf16 v[20:23], a[0:3], a[44:47], v[20:23]
    ds_read_b128 a[116:119], v73 offset:1216
    v_mfma_f32_16x16x32_bf16 v[16:19], a[0:3], a[40:43], v[16:19]
    ds_read_b128 a[112:115], v73 offset:1728
    v_mfma_f32_16x16x32_bf16 v[12:15], a[0:3], a[36:39], v[12:15]
    ds_read_b128 a[108:111], v73 offset:2240
    v_mfma_f32_16x16x32_bf16 v[8:11], a[0:3], a[32:35], v[8:11]
    ds_read_b128 a[104:107], v73 offset:2752
    v_mfma_f32_16x16x32_bf16 v[36:39], a[4:7], a[56:59], v[36:39]
    ds_read_b128 a[100:103], v73 offset:3264
    v_mfma_f32_16x16x32_bf16 v[32:35], a[4:7], a[52:55], v[32:35]
    ds_read_b128 a[96:99], v73 offset:3776
    v_mfma_f32_16x16x32_bf16 v[28:31], a[4:7], a[48:51], v[28:31]
    ds_read_b64 a[68:69], v72 offset:704
    v_mfma_f32_16x16x32_bf16 v[24:27], a[4:7], a[44:47], v[24:27]
    ds_read_b64 a[70:71], v72 offset:712
    v_mfma_f32_16x16x32_bf16 v[20:23], a[4:7], a[40:43], v[20:23]
    ds_read_b64 a[72:73], v72 offset:1216
    v_mfma_f32_16x16x32_bf16 v[16:19], a[4:7], a[36:39], v[16:19]
    ds_read_b64 a[74:75], v72 offset:1224
    v_mfma_f32_16x16x32_bf16 v[12:15], a[4:7], a[32:35], v[12:15]
    s_waitcnt lgkmcnt(15)
    ds_read_b64 a[76:77], v72 offset:1728
    v_mfma_f32_16x16x32_bf16 v[36:39], a[8:11], a[52:55], v[36:39]
    ds_read_b64 a[78:79], v72 offset:1736
    v_mfma_f32_16x16x32_bf16 v[32:35], a[8:11], a[48:51], v[32:35]
    ds_read_b64 a[80:81], v72 offset:2240
    v_mfma_f32_16x16x32_bf16 v[28:31], a[8:11], a[44:47], v[28:31]
    ds_read_b64 a[82:83], v72 offset:2248
    v_mfma_f32_16x16x32_bf16 v[24:27], a[8:11], a[40:43], v[24:27]
    ds_read_b64 a[84:85], v72 offset:2752
    v_mfma_f32_16x16x32_bf16 v[20:23], a[8:11], a[36:39], v[20:23]
    ds_read_b64 a[86:87], v72 offset:2760
    v_mfma_f32_16x16x32_bf16 v[16:19], a[8:11], a[32:35], v[16:19]
    ds_read_b64 a[88:89], v72 offset:3264
    v_mfma_f32_16x16x32_bf16 v[36:39], a[12:15], a[48:51], v[36:39]
    ds_read_b64 a[90:91], v72 offset:3272
    v_mfma_f32_16x16x32_bf16 v[32:35], a[12:15], a[44:47], v[32:35]
    ds_read_b64 a[92:93], v72 offset:3776
    v_mfma_f32_16x16x32_bf16 v[28:31], a[12:15], a[40:43], v[28:31]
    ds_read_b64 a[94:95], v72 offset:3784
    v_mfma_f32_16x16x32_bf16 v[24:27], a[12:15], a[36:39], v[24:27]
    ds_read_b64 v[60:61], v74 offset:512
    v_mfma_f32_16x16x32_bf16 v[20:23], a[12:15], a[32:35], v[20:23]
    ds_read_b64 v[62:63], v74 offset:0
    v_and_b32 v40, s90, v57
    v_mfma_f32_16x16x32_bf16 v[36:39], a[16:19], a[44:47], v[36:39]
    v_lshlrev_b32 v41, 16, v57
    v_and_b32 v42, s90, v56
    v_mfma_f32_16x16x32_bf16 v[32:35], a[16:19], a[40:43], v[32:35]
    v_lshlrev_b32 v43, 16, v56
    v_mul_f32 v40, s55, v40
    v_mfma_f32_16x16x32_bf16 v[28:31], a[16:19], a[36:39], v[28:31]
    v_mul_f32 v41, s55, v41
    v_mul_f32 v42, s55, v42
    v_mfma_f32_16x16x32_bf16 v[24:27], a[16:19], a[32:35], v[24:27]
    v_mul_f32 v43, s55, v43
    s_waitcnt lgkmcnt(15)
    v_and_b32 v44, s90, v59
    v_mfma_f32_16x16x32_bf16 v[36:39], a[20:23], a[40:43], v[36:39]
    v_lshlrev_b32 v45, 16, v59
    v_and_b32 v46, s90, v58
    v_mfma_f32_16x16x32_bf16 v[32:35], a[20:23], a[36:39], v[32:35]
    v_lshlrev_b32 v47, 16, v58
    v_mul_f32 v44, s55, v44
    v_mfma_f32_16x16x32_bf16 v[28:31], a[20:23], a[32:35], v[28:31]
    v_mul_f32 v45, s55, v45
    v_mul_f32 v46, s55, v46
    v_mfma_f32_16x16x32_bf16 v[36:39], a[24:27], a[36:39], v[36:39]
    v_mul_f32 v47, s55, v47
    s_waitcnt lgkmcnt(1)
    v_and_b32 v48, s90, v61
    v_mfma_f32_16x16x32_bf16 v[32:35], a[24:27], a[32:35], v[32:35]
    v_lshlrev_b32 v49, 16, v61
    v_and_b32 v50, s90, v60
    v_mfma_f32_16x16x32_bf16 v[36:39], a[28:31], a[32:35], v[36:39]
    v_lshlrev_b32 v51, 16, v60
    v_mul_f32 v48, s55, v48
    v_mul_f32 v49, s55, v49
    v_mul_f32 v50, s55, v50
    v_mul_f32 v51, s55, v51
    s_waitcnt lgkmcnt(0)
    v_and_b32 v52, s90, v63
    v_lshlrev_b32 v53, 16, v63
    v_and_b32 v54, s90, v62
    v_lshlrev_b32 v55, 16, v62
    v_mul_f32 v52, s55, v52
    v_mul_f32 v53, s55, v53
    v_mul_f32 v54, s55, v54
    v_mul_f32 v55, s55, v55
    v_and_b32 v64, 1, v0
    v_lshlrev_b32 v64, 7, v64
    s_lshl_b32 s42, s51, 8
    s_add_u32 s42, s42, 196608
    buffer_load_dword v65, v64, s[4:7], s42 offen sc1
    s_cmp_ge_u32 s46, 2
    s_cbranch_scc1 L_cv10
    v_mfma_f32_16x16x32_bf16 v[32:35], a[64:67], a[120:123], v[32:35]
    v_mfma_f32_16x16x32_bf16 v[32:35], a[68:71], a[116:119], v[32:35]
    v_mfma_f32_16x16x32_bf16 v[32:35], a[72:75], a[112:115], v[32:35]
    v_mfma_f32_16x16x32_bf16 v[32:35], a[76:79], a[108:111], v[32:35]
    v_mfma_f32_16x16x32_bf16 v[32:35], a[80:83], a[104:107], v[32:35]
    v_mfma_f32_16x16x32_bf16 v[32:35], a[84:87], a[100:103], v[32:35]
    v_mfma_f32_16x16x32_bf16 v[32:35], a[88:91], a[96:99], v[32:35]
    v_mfma_f32_16x16x32_bf16 v[28:31], a[64:67], a[116:119], v[28:31]
    v_mfma_f32_16x16x32_bf16 v[28:31], a[68:71], a[112:115], v[28:31]
    v_mfma_f32_16x16x32_bf16 v[28:31], a[72:75], a[108:111], v[28:31]
    v_mfma_f32_16x16x32_bf16 v[28:31], a[76:79], a[104:107], v[28:31]
    v_mfma_f32_16x16x32_bf16 v[28:31], a[80:83], a[100:103], v[28:31]
    v_mfma_f32_16x16x32_bf16 v[28:31], a[84:87], a[96:99], v[28:31]
    v_mfma_f32_16x16x32_bf16 v[24:27], a[64:67], a[112:115], v[24:27]
    v_mfma_f32_16x16x32_bf16 v[24:27], a[68:71], a[108:111], v[24:27]
    ds_write_b128 v75, v[32:35] offset:2048
    v_mfma_f32_16x16x32_bf16 v[24:27], a[72:75], a[104:107], v[24:27]
    v_mfma_f32_16x16x32_bf16 v[24:27], a[76:79], a[100:103], v[24:27]
    v_mfma_f32_16x16x32_bf16 v[24:27], a[80:83], a[96:99], v[24:27]
    v_mfma_f32_16x16x32_bf16 v[36:39], a[64:67], a[124:127], v[36:39]
    v_mfma_f32_16x16x32_bf16 v[36:39], a[68:71], a[120:123], v[36:39]
    v_mfma_f32_16x16x32_bf16 v[36:39], a[72:75], a[116:119], v[36:39]
    ds_write_b128 v75, v[28:31] offset:1024
    v_mfma_f32_16x16x32_bf16 v[36:39], a[76:79], a[112:115], v[36:39]
    v_mfma_f32_16x16x32_bf16 v[36:39], a[80:83], a[108:111], v[36:39]
    v_mfma_f32_16x16x32_bf16 v[36:39], a[84:87], a[104:107], v[36:39]
    v_mfma_f32_16x16x32_bf16 v[36:39], a[88:91], a[100:103], v[36:39]
    v_mfma_f32_16x16x32_bf16 v[36:39], a[92:95], a[96:99], v[36:39]
    ds_write_b128 v75, v[24:27] offset:0
    v_mfma_f32_16x16x32_bf16 v[20:23], a[64:67], a[108:111], v[20:23]
    v_mfma_f32_16x16x32_bf16 v[20:23], a[68:71], a[104:107], v[20:23]
    v_mfma_f32_16x16x32_bf16 v[20:23], a[72:75], a[100:103], v[20:23]
    v_mfma_f32_16x16x32_bf16 v[124:127], a[76:79], a[96:99], v[20:23]
    v_mfma_f32_16x16x32_bf16 v[16:19], a[64:67], a[104:107], v[16:19]
    v_mfma_f32_16x16x32_bf16 v[16:19], a[68:71], a[100:103], v[16:19]
    v_mfma_f32_16x16x32_bf16 v[120:123], a[72:75], a[96:99], v[16:19]
    v_mfma_f32_16x16x32_bf16 v[12:15], a[64:67], a[100:103], v[12:15]
    ds_write_b128 v75, v[36:39] offset:3072
    v_mfma_f32_16x16x32_bf16 v[116:119], a[68:71], a[96:99], v[12:15]
    v_mfma_f32_16x16x32_bf16 v[112:115], a[64:67], a[96:99], v[8:11]
    s_branch L_cv11
L_cv10:
    v_mfma_f32_16x16x32_bf16 v[20:23], a[64:67], a[108:111], v[20:23]
    v_mfma_f32_16x16x32_bf16 v[20:23], a[68:71], a[104:107], v[20:23]
    v_mfma_f32_16x16x32_bf16 v[20:23], a[72:75], a[100:103], v[20:23]
    v_mfma_f32_16x16x32_bf16 v[20:23], a[76:79], a[96:99], v[20:23]
    v_mfma_f32_16x16x32_bf16 v[16:19], a[64:67], a[104:107], v[16:19]
    v_mfma_f32_16x16x32_bf16 v[16:19], a[68:71], a[100:103], v[16:19]
    v_mfma_f32_16x16x32_bf16 v[16:19], a[72:75], a[96:99], v[16:19]
    v_mfma_f32_16x16x32_bf16 v[12:15], a[64:67], a[100:103], v[12:15]
    v_mfma_f32_16x16x32_bf16 v[12:15], a[68:71], a[96:99], v[12:15]
    v_mfma_f32_16x16x32_bf16 v[8:11], a[64:67], a[96:99], v[8:11]
    v_mfma_f32_16x16x32_bf16 v[36:39], a[64:67], a[124:127], v[36:39]
    v_mfma_f32_16x16x32_bf16 v[36:39], a[68:71], a[120:123], v[36:39]
    ds_write_b128 v75, v[20:23] offset:3072
    v_mfma_f32_16x16x32_bf16 v[36:39], a[72:75], a[116:119], v[36:39]
    v_mfma_f32_16x16x32_bf16 v[36:39], a[76:79], a[112:115], v[36:39]
    v_mfma_f32_16x16x32_bf16 v[36:39], a[80:83], a[108:111], v[36:39]
    ds_write_b128 v75, v[16:19] offset:2048
    v_mfma_f32_16x16x32_bf16 v[36:39], a[84:87], a[104:107], v[36:39]
    v_mfma_f32_16x16x32_bf16 v[36:39], a[88:91], a[100:103], v[36:39]
    ds_write_b128 v75, v[12:15] offset:1024
    v_mfma_f32_16x16x32_bf16 v[124:127], a[92:95], a[96:99], v[36:39]
    ds_write_b128 v75, v[8:11] offset:0
    v_mfma_f32_16x16x32_bf16 v[32:35], a[64:67], a[120:123], v[32:35]
    v_mfma_f32_16x16x32_bf16 v[32:35], a[68:71], a[116:119], v[32:35]
    v_mfma_f32_16x16x32_bf16 v[32:35], a[72:75], a[112:115], v[32:35]
    v_mfma_f32_16x16x32_bf16 v[32:35], a[76:79], a[108:111], v[32:35]
    v_mfma_f32_16x16x32_bf16 v[32:35], a[80:83], a[104:107], v[32:35]
    v_mfma_f32_16x16x32_bf16 v[32:35], a[84:87], a[100:103], v[32:35]
    v_mfma_f32_16x16x32_bf16 v[120:123], a[88:91], a[96:99], v[32:35]
    v_mfma_f32_16x16x32_bf16 v[28:31], a[64:67], a[116:119], v[28:31]
    v_mfma_f32_16x16x32_bf16 v[28:31], a[68:71], a[112:115], v[28:31]
    v_mfma_f32_16x16x32_bf16 v[28:31], a[72:75], a[108:111], v[28:31]
    v_mfma_f32_16x16x32_bf16 v[28:31], a[76:79], a[104:107], v[28:31]
    v_mfma_f32_16x16x32_bf16 v[28:31], a[80:83], a[100:103], v[28:31]
    v_mfma_f32_16x16x32_bf16 v[116:119], a[84:87], a[96:99], v[28:31]
    v_mfma_f32_16x16x32_bf16 v[24:27], a[64:67], a[112:115], v[24:27]
    v_mfma_f32_16x16x32_bf16 v[24:27], a[68:71], a[108:111], v[24:27]
    v_mfma_f32_16x16x32_bf16 v[24:27], a[72:75], a[104:107], v[24:27]
    v_mfma_f32_16x16x32_bf16 v[24:27], a[76:79], a[100:103], v[24:27]
    v_mfma_f32_16x16x32_bf16 v[112:115], a[80:83], a[96:99], v[24:27]
L_cv11:
    s_waitcnt lgkmcnt(0)
    s_barrier
    ds_read_b128 v[8:11], v69 offset:0
    s_nop 0
    ds_read_b128 v[12:15], v69 offset:1024
    ds_read_b128 v[16:19], v69 offset:2048
    ds_read_b128 v[20:23], v69 offset:3072
    s_nop 0
    v_pk_add_f32 v[40:41], v[40:41], v[112:113]
    v_pk_add_f32 v[42:43], v[42:43], v[114:115]
    v_pk_add_f32 v[44:45], v[44:45], v[116:117]
    v_pk_add_f32 v[46:47], v[46:47], v[118:119]
    v_pk_add_f32 v[48:49], v[48:49], v[120:121]
    v_pk_add_f32 v[50:51], v[50:51], v[122:123]
    v_pk_add_f32 v[52:53], v[52:53], v[124:125]
    v_pk_add_f32 v[54:55], v[54:55], v[126:127]
    s_waitcnt lgkmcnt(3)
    v_pk_add_f32 v[40:41], v[40:41], v[8:9]
    v_pk_add_f32 v[42:43], v[42:43], v[10:11]
    v_cvt_pk_bf16_f32 v24, v40, v41
    v_cvt_pk_bf16_f32 v25, v42, v43
    s_waitcnt lgkmcnt(2)
    v_pk_add_f32 v[44:45], v[44:45], v[12:13]
    v_pk_add_f32 v[46:47], v[46:47], v[14:15]
    v_cvt_pk_bf16_f32 v26, v44, v45
    v_cvt_pk_bf16_f32 v27, v46, v47
    s_nop 0
    v_permlane16_swap_b32 v24, v26
    v_permlane16_swap_b32 v25, v27
    buffer_store_dwordx4 v[24:27], v67, s[4:7], s40 offen sc1
    s_waitcnt lgkmcnt(1)
    v_pk_add_f32 v[48:49], v[48:49], v[16:17]
    v_pk_add_f32 v[50:51], v[50:51], v[18:19]
    v_cvt_pk_bf16_f32 v28, v48, v49
    v_cvt_pk_bf16_f32 v29, v50, v51
    s_waitcnt lgkmcnt(0)
    v_pk_add_f32 v[52:53], v[52:53], v[20:21]
    v_pk_add_f32 v[54:55], v[54:55], v[22:23]
    v_cvt_pk_bf16_f32 v30, v52, v53
    v_cvt_pk_bf16_f32 v31, v54, v55
    s_nop 0
    v_permlane16_swap_b32 v28, v30
    v_permlane16_swap_b32 v29, v31
    buffer_store_dwordx4 v[28:31], v67, s[4:7], s41 offen sc1
    s_cmp_lg_u32 s49, 0
    s_cbranch_scc1 L_ool12
L_back13:
    s_mov_b64 exec, 1
    buffer_store_dword v98, v87, s[4:7], s69 offen
    s_mov_b64 exec, -1
    v_and_b32 v83, 0x1f0, v1
    v_lshrrev_b32 v8, 5, v0
    v_lshl_add_u32 v83, v8, 3, v83
    s_lshl_b32 s3, s54, 9
    s_add_u32 s3, s3, 1048576
    s_cmp_eq_u32 s46, 0
    s_cselect_b32 s3, s3, 0x40000000
    v_readlane_b32 s76, v79, 6
    v_readlane_b32 s73, v78, 6
    s_mov_b32 m0, s76
    s_nop 3
    buffer_load_dwordx4 v6, s[28:31], s73 offen lds
    v_readlane_b32 s76, v79, 7
    v_readlane_b32 s73, v78, 7
    s_mov_b32 m0, s76
    s_nop 3
    buffer_load_dwordx4 v6, s[28:31], s73 offen lds
    v_readlane_b32 s76, v79, 8
    v_readlane_b32 s73, v78, 8
    s_mov_b32 m0, s76
    s_nop 3
    buffer_load_dwordx4 v6, s[28:31], s73 offen lds
    v_readlane_b32 s76, v79, 9
    v_readlane_b32 s73, v78, 9
    s_mov_b32 m0, s76
    s_nop 3
    buffer_load_dwordx4 v6, s[28:31], s73 offen lds
    v_readlane_b32 s76, v79, 10
    v_readlane_b32 s73, v78, 10
    s_mov_b32 m0, s76
    s_nop 3
    buffer_load_dwordx4 v6, s[28:31], s73 offen lds
    v_readlane_b32 s76, v79, 11
    v_readlane_b32 s73, v78, 11
    s_mov_b32 m0, s76
    s_nop 3
    buffer_load_dwordx4 v6, s[28:31], s73 offen lds
    s_waitcnt vmcnt(17)
    v_lshlrev_b32 v112, 16, v104
    v_and_b32 v113, s90, v104
    v_lshlrev_b32 v114, 16, v105
    v_and_b32 v115, s90, v105
    v_lshlrev_b32 v116, 16, v106
    v_and_b32 v117, s90, v106
    v_lshlrev_b32 v118, 16, v107
    v_and_b32 v119, s90, v107
    s_waitcnt vmcnt(16)
    v_lshlrev_b32 v120, 16, v108
    v_and_b32 v121, s90, v108
    v_lshlrev_b32 v122, 16, v109
    v_and_b32 v123, s90, v109
    v_lshlrev_b32 v124, 16, v110
    v_and_b32 v125, s90, v110
    v_lshlrev_b32 v126, 16, v111
    v_and_b32 v127, s90, v111
    v_pk_add_f32 v[16:17], v[112:113], v[114:115]
    v_pk_mul_f32 v[18:19], v[112:113], v[112:113]
    v_pk_add_f32 v[16:17], v[16:17], v[116:117]
    v_pk_fma_f32 v[18:19], v[114:115], v[114:115], v[18:19]
    v_pk_add_f32 v[16:17], v[16:17], v[118:119]
    v_pk_fma_f32 v[18:19], v[116:117], v[116:117], v[18:19]
    v_pk_fma_f32 v[18:19], v[118:119], v[118:119], v[18:19]
    v_pk_add_f32 v[20:21], v[120:121], v[122:123]
    v_pk_mul_f32 v[22:23], v[120:121], v[120:121]
    v_pk_add_f32 v[20:21], v[20:21], v[124:125]
    v_pk_fma_f32 v[22:23], v[122:123], v[122:123], v[22:23]
    v_pk_add_f32 v[20:21], v[20:21], v[126:127]
    v_pk_fma_f32 v[22:23], v[124:125], v[124:125], v[22:23]
    v_pk_fma_f32 v[22:23], v[126:127], v[126:127], v[22:23]
    v_add_f32 v16, v16, v17
    v_add_f32 v18, v18, v19
    v_add_f32 v20, v20, v21
    v_add_f32 v22, v22, v23
    s_lshl_b32 s58, s46, 2
    s_add_u32 s58, s58, 32768
    v_permlane32_swap_b32 v16, v18
    v_permlane32_swap_b32 v20, v22
    v_add_f32 v16, v16, v18
    v_add_f32 v20, v20, v22
    v_add_u32 v17, s58, v1
    s_nop 0
    v_permlane16_swap_b32 v16, v20
    v_add_f32 v16, v16, v20
    ds_write_b32 v17, v16
    v_lshrrev_b32 v10, 4, v0
    v_bfe_u32 v11, v0, 2, 2
    v_and_b32 v12, 3, v0
    v_lshl_add_u32 v13, v10, 3, v11
    v_lshlrev_b32 v13, 6, v13
    v_lshl_add_u32 v13, v12, 3, v13
    v_and_b32 v14, 1, v10
    v_lshl_add_u32 v41, v14, 5, v13
    s_and_b32 s58, s46, 1
    s_lshl_b32 s58, s58, 5
    v_xor_b32 v76, s58, v41
    v_add_u32 v77, 131072, v76
    v_add_u32 v76, 65536, v76
    s_lshl_b32 s58, s46, 11
    s_add_u32 s58, s58, 0
    v_add_u32 v44, s58, v13
    v_add_u32 v45, s58, v1
    v_lshrrev_b32 v47, 2, v0
    v_lshlrev_b32 v47, 7, v47
    v_lshl_add_u32 v47, v12, 4, v47
    s_lshl_b32 s58, s51, 2
    s_add_u32 s58, s58, s46
    s_lshl_b32 s64, s58, 12
    s_lshr_b32 s60, s50, 1
    s_lshl_b32 s60, s60, 16
    s_add_u32 s64, s64, s60
    s_and_b32 s60, s50, 1
    s_lshl_b32 s60, s60, 6
    s_add_u32 s64, s64, s60
    s_add_u32 s64, s64, 2097152
    s_lshl_b32 s68, s44, 9
    s_add_u32 s68, s68, 24576
    v_and_b32 v46, 31, v0
    v_lshlrev_b32 v46, 2, v46
    s_waitcnt vmcnt(0)
    s_waitcnt lgkmcnt(0)
    s_barrier
    ds_read_b128 v[16:19], v1 offset:32768
    s_add_u32 s58, s3, 0
    s_add_u32 s70, s48, 1013904242
    s_waitcnt lgkmcnt(0)
    v_pk_add_f32 v[16:17], v[16:17], v[18:19]
    v_add_f32 v16, v16, v17
    v_xor_b32 v17, s70, v16
    buffer_store_dwordx2 v[16:17], v83, s[4:7], s58 offen
    s_cmp_lg_u32 s49, 0
    s_cbranch_scc1 L_ool14
L_back15:
    v_cmp_ne_u32 vcc, s48, v65
    s_cbranch_vccnz L_ool16
L_back17:
    v_readlane_b32 s76, v79, 12
    v_readlane_b32 s73, v78, 12
    s_mov_b32 m0, s76
    s_nop 3
    buffer_load_dwordx4 v6, s[28:31], s73 offen lds
    ds_read_b64_tr_b16 a[0:1], v76 offset:0
    ds_read_b64_tr_b16 a[2:3], v76 offset:256
    ds_read_b64_tr_b16 a[4:5], v76 offset:2048
    ds_read_b64_tr_b16 a[6:7], v76 offset:2304
    ds_read_b64_tr_b16 a[8:9], v76 offset:4096
    v_readlane_b32 s76, v79, 13
    v_readlane_b32 s73, v78, 13
    s_mov_b32 m0, s76
    s_nop 3
    buffer_load_dwordx4 v6, s[28:31], s73 offen lds
    ds_read_b64_tr_b16 a[10:11], v76 offset:4352
    ds_read_b64_tr_b16 a[12:13], v76 offset:6144
    ds_read_b64_tr_b16 a[14:15], v76 offset:6400
    ds_read_b64_tr_b16 a[16:17], v76 offset:8192
    ds_read_b64_tr_b16 a[18:19], v76 offset:8448
    v_readlane_b32 s76, v79, 14
    v_readlane_b32 s73, v78, 14
    s_mov_b32 m0, s76
    s_nop 3
    buffer_load_dwordx4 v6, s[28:31], s73 offen lds
    ds_read_b64_tr_b16 a[20:21], v76 offset:10240
    ds_read_b64_tr_b16 a[22:23], v76 offset:10496
    ds_read_b64_tr_b16 a[24:25], v76 offset:12288
    ds_read_b64_tr_b16 a[26:27], v76 offset:12544
    ds_read_b64_tr_b16 a[28:29], v76 offset:14336
    v_readlane_b32 s76, v79, 15
    v_readlane_b32 s73, v78, 15
    s_mov_b32 m0, s76
    s_nop 3
    buffer_load_dwordx4 v6, s[28:31], s73 offen lds
    ds_read_b64_tr_b16 a[30:31], v76 offset:14592
    ds_read_b64_tr_b16 a[32:33], v76 offset:16384
    ds_read_b64_tr_b16 a[34:35], v76 offset:16640
    ds_read_b64_tr_b16 a[36:37], v76 offset:18432
    ds_read_b64_tr_b16 a[38:39], v76 offset:18688
    v_readlane_b32 s76, v79, 16
    v_readlane_b32 s73, v78, 16
    s_mov_b32 m0, s76
    s_nop 3
    buffer_load_dwordx4 v6, s[28:31], s73 offen lds
    ds_read_b64_tr_b16 a[40:41], v76 offset:20480
    ds_read_b64_tr_b16 a[42:43], v76 offset:20736
    ds_read_b64_tr_b16 a[44:45], v76 offset:22528
    ds_read_b64_tr_b16 a[46:47], v76 offset:22784
    ds_read_b64_tr_b16 a[48:49], v76 offset:24576
    v_readlane_b32 s76, v79, 17
    v_readlane_b32 s73, v78, 17
    s_mov_b32 m0, s76
    s_nop 3
    buffer_load_dwordx4 v6, s[28:31], s73 offen lds
    ds_read_b64_tr_b16 a[50:51], v76 offset:24832
    ds_read_b64_tr_b16 a[52:53], v76 offset:26624
    ds_read_b64_tr_b16 a[54:55], v76 offset:26880
    ds_read_b64_tr_b16 a[56:57], v76 offset:28672
    ds_read_b64_tr_b16 a[58:59], v76 offset:28928
    s_lshl_b32 s69, s50, 11
    s_add_u32 s69, s69, 1048576
    buffer_load_dwordx4 v[8:11], v1, s[4:7], s69 offen offset:0 sc1
    buffer_load_dwordx4 v[12:15], v1, s[4:7], s69 offen offset:1024 sc1
    buffer_load_dword v48, v46, s[4:7], s68 offen sc1
    buffer_load_dwordx4 v[24:27], v47, s[4:7], s64 offen sc1
    buffer_load_dwordx4 v[28:31], v47, s[4:7], s64 offen offset:2048 sc1
    ds_read_b64_tr_b16 a[60:61], v76 offset:30720
    ds_read_b64_tr_b16 a[62:63], v76 offset:30976
    s_add_u32 s70, s48, 1013904242
    s_waitcnt vmcnt(4)
    v_bitop3_b32 v16, v8, v9, s70 bitop3:0x96
    v_bitop3_b32 v17, v10, v11, s70 bitop3:0x96
    s_waitcnt vmcnt(3)
    v_bitop3_b32 v18, v12, v13, s70 bitop3:0x96
    v_bitop3_b32 v19, v14, v15, s70 bitop3:0x96
    v_or3_b32 v16, v16, v17, v18
    v_or_b32 v16, v16, v19
    v_cmp_ne_u32 vcc, 0, v16
    s_cbranch_vccnz L_ool18
L_back19:
    v_add_f32 v8, v8, v12
    v_add_f32 v10, v10, v14
    s_nop 1
    v_permlane32_swap_b32 v8, v10
    v_add_f32 v8, v8, v10
    v_mul_f32 v8, s93, v8
    v_mov_b32 v9, v8
    s_nop 1
    v_permlane32_swap_b32 v8, v9
    v_fma_f32 v9, -v8, v8, v9
    v_cvt_pk_bf16_f32 v8, v8, v8
    v_max_f32 v9, 0, v9
    v_add_f32 v9, s94, v9
    v_rsq_f32 v9, v9
    v_and_b32 v8, s90, v8
    v_mul_f32 v10, -v8, v9
    v_mov_b32 v12, v9
    v_mov_b32 v8, v9
    v_mov_b32 v13, v10
    v_mov_b32 v9, v10
    v_permlane16_swap_b32 v8, v12
    s_nop 0
    v_permlane16_swap_b32 v9, v13
    v_pk_fma_f32 v[56:57], v[112:113], v[8:9], v[8:9] op_sel:[0,0,1] op_sel_hi:[1,0,1]
    v_pk_fma_f32 v[58:59], v[114:115], v[8:9], v[8:9] op_sel:[0,0,1] op_sel_hi:[1,0,1]
    v_pk_fma_f32 v[60:61], v[116:117], v[8:9], v[8:9] op_sel:[0,0,1] op_sel_hi:[1,0,1]
    v_pk_fma_f32 v[62:63], v[118:119], v[8:9], v[8:9] op_sel:[0,0,1] op_sel_hi:[1,0,1]
    v_pk_fma_f32 v[64:65], v[120:121], v[12:13], v[12:13] op_sel:[0,0,1] op_sel_hi:[1,0,1]
    v_pk_fma_f32 v[66:67], v[122:123], v[12:13], v[12:13] op_sel:[0,0,1] op_sel_hi:[1,0,1]
    v_pk_fma_f32 v[68:69], v[124:125], v[12:13], v[12:13] op_sel:[0,0,1] op_sel_hi:[1,0,1]
    v_pk_fma_f32 v[70:71], v[126:127], v[12:13], v[12:13] op_sel:[0,0,1] op_sel_hi:[1,0,1]
    s_waitcnt vmcnt(2)
    v_cmp_ne_u32 vcc, s47, v48
    s_cbranch_vccnz L_ool20
L_back21:
    s_waitcnt vmcnt(1)
    v_max3_u32 v32, v24, v25, v26
    s_waitcnt vmcnt(0)
    v_max3_u32 v33, v27, v28, v29
    v_max3_u32 v32, v32, v30, v31
    v_max_u32 v32, v32, v33
    v_cmp_eq_u32 vcc, -1, v32
    s_cbranch_vccnz L_ool22
L_back23:
    ds_write_b128 v45, v[24:27]
    ds_write_b128 v45, v[28:31] offset:1024
    s_waitcnt lgkmcnt(0)
    ds_read_b64_tr_b16 v[104:105], v44 offset:0
    ds_read_b64_tr_b16 v[106:107], v44 offset:256
    ds_read_b64_tr_b16 v[108:109], v44 offset:32
    ds_read_b64_tr_b16 v[110:111], v44 offset:288
    s_lshl_b32 s58, s51, 2
    s_add_u32 s60, s58, s46
    s_lshl_b32 s58, s60, 10
    s_lshl_b32 s59, s50, 15
    s_add_u32 s58, s58, s59
    s_add_u32 s64, s58, 0
    s_add_u32 s65, s64, 0x4000
    s_lshl_b32 s68, s50, 4
    s_add_u32 s68, s68, s60
    s_lshl_b32 s68, s68, 2
    s_add_u32 s68, s68, 8192
    s_waitcnt lgkmcnt(3)
    v_lshlrev_b32 v24, 16, v104
    v_and_b32 v25, s90, v104
    v_lshlrev_b32 v26, 16, v105
    v_and_b32 v27, s90, v105
    s_waitcnt lgkmcnt(2)
    v_lshlrev_b32 v28, 16, v106
    v_and_b32 v29, s90, v106
    v_lshlrev_b32 v30, 16, v107
    v_and_b32 v31, s90, v107
    s_waitcnt lgkmcnt(1)
    v_lshlrev_b32 v32, 16, v108
    v_and_b32 v33, s90, v108
    v_lshlrev_b32 v34, 16, v109
    v_and_b32 v35, s90, v109
    s_waitcnt lgkmcnt(0)
    v_lshlrev_b32 v36, 16, v110
    v_and_b32 v37, s90, v110
    v_lshlrev_b32 v38, 16, v111
    v_and_b32 v39, s90, v111
    v_pk_fma_f32 v[112:113], v[56:57], v[24:25], v[112:113]
    v_pk_fma_f32 v[114:115], v[58:59], v[26:27], v[114:115]
    v_pk_fma_f32 v[116:117], v[60:61], v[28:29], v[116:117]
    v_pk_fma_f32 v[118:119], v[62:63], v[30:31], v[118:119]
    v_cvt_pk_bf16_f32 v40, v112, v113
    v_cvt_pk_bf16_f32 v41, v114, v115
    v_cvt_pk_bf16_f32 v42, v116, v117
    v_cvt_pk_bf16_f32 v43, v118, v119
    buffer_store_dwordx4 v[40:43], v1, s[36:39], s64 offen
    v_pk_fma_f32 v[120:121], v[64:65], v[32:33], v[120:121]
    v_pk_fma_f32 v[122:123], v[66:67], v[34:35], v[122:123]
    v_pk_fma_f32 v[124:125], v[68:69], v[36:37], v[124:125]
    v_pk_fma_f32 v[126:127], v[70:71], v[38:39], v[126:127]
    v_cvt_pk_bf16_f32 v44, v120, v121
    v_cvt_pk_bf16_f32 v45, v122, v123
    v_cvt_pk_bf16_f32 v46, v124, v125
    v_cvt_pk_bf16_f32 v47, v126, v127
    buffer_store_dwordx4 v[44:47], v1, s[36:39], s65 offen
    v_pk_add_f32 v[16:17], v[112:113], v[114:115]
    v_pk_mul_f32 v[18:19], v[112:113], v[112:113]
    v_pk_add_f32 v[16:17], v[16:17], v[116:117]
    v_pk_fma_f32 v[18:19], v[114:115], v[114:115], v[18:19]
    v_pk_add_f32 v[16:17], v[16:17], v[118:119]
    v_pk_fma_f32 v[18:19], v[116:117], v[116:117], v[18:19]
    v_pk_fma_f32 v[18:19], v[118:119], v[118:119], v[18:19]
    v_pk_add_f32 v[20:21], v[120:121], v[122:123]
    v_pk_mul_f32 v[22:23], v[120:121], v[120:121]
    v_pk_add_f32 v[20:21], v[20:21], v[124:125]
    v_pk_fma_f32 v[22:23], v[122:123], v[122:123], v[22:23]
    v_pk_add_f32 v[20:21], v[20:21], v[126:127]
    v_pk_fma_f32 v[22:23], v[124:125], v[124:125], v[22:23]
    v_pk_fma_f32 v[22:23], v[126:127], v[126:127], v[22:23]
    v_add_f32 v16, v16, v17
    v_add_f32 v18, v18, v19
    v_add_f32 v20, v20, v21
    v_add_f32 v22, v22, v23
    s_lshl_b32 s58, s46, 2
    s_add_u32 s58, s58, 16384
    v_permlane32_swap_b32 v16, v18
    v_permlane32_swap_b32 v20, v22
    v_add_f32 v16, v16, v18
    v_add_f32 v20, v20, v22
    v_add_u32 v17, s58, v1
    s_nop 0
    v_permlane16_swap_b32 v16, v20
    v_add_f32 v16, v16, v20
    ds_write_b32 v17, v16
    s_waitcnt lgkmcnt(0)
    s_barrier
    ds_read_b128 v[16:19], v1 offset:16384
    s_add_u32 s58, s3, 131072
    s_add_u32 s70, s48, 2027808484
    s_waitcnt lgkmcnt(0)
    v_pk_add_f32 v[16:17], v[16:17], v[18:19]
    v_add_f32 v16, v16, v17
    v_xor_b32 v17, s70, v16
    buffer_store_dwordx2 v[16:17], v83, s[4:7], s58 offen
    s_cmp_lg_u32 s49, 0
    s_cbranch_scc1 L_ool24
L_back25:
    s_lshl_b32 s71, s52, 8
    s_add_u32 s72, s71, 28672
    s_add_u32 s71, s71, 8192
    s_lshl_b32 s58, s53, 2
    s_add_u32 s72, s72, s58
    s_lshl_b32 s78, s52, 2
    s_add_u32 s78, s78, s46
    s_lshl_b32 s78, s78, 11
    s_add_u32 s78, s78, 1179648
    s_lshr_b32 s58, s46, 1
    s_lshl_b32 s79, s58, 16
    s_and_b32 s58, s46, 1
    s_lshl_b32 s58, s58, 13
    s_add_u32 s66, s79, s58
    v_lshlrev_b32 v40, 2, v0
    s_lshl_b32 s67, s52, 17
    s_add_u32 s67, s67, 0
    v_add_u32 v192, s67, v1
    v_add_u32 v5, s79, v1
    v_lshrrev_b32 v41, 4, v0
    v_lshlrev_b32 v198, 4, v41
    s_lshr_b32 s58, s79, 8
    s_add_u32 s58, s58, 131072
    v_add_u32 v198, s58, v198
    v_and_b32 v41, 15, v0
    v_lshlrev_b32 v41, 2, v41
    v_add_u32 v193, s58, v41
    v_and_b32 v41, 31, v0
    v_lshrrev_b32 v42, 5, v0
    v_lshlrev_b32 v41, 2, v41
    s_lshl_b32 s58, s46, 7
    s_add_u32 s58, s58, 131072
    v_add_u32 v41, s58, v41
    v_lshl_add_u32 v194, v42, 9, v41
    v_mov_b32 v84, 0x3f317218
    v_mov_b32 v85, s91
    s_lshl_b32 s58, s46, 11
    s_add_u32 s58, s58, 139264
    v_add_u32 v4, s58, v1
    v_and_b32 v80, 15, v0
    v_cmp_eq_u32 vcc, 0, v80
    v_mov_b32 v81, 0x40000000
    v_lshlrev_b32 v208, 6, v80
    v_lshlrev_b32 v210, 2, v80
    v_cndmask_b32 v211, v81, v0, vcc
    v_lshrrev_b32 v80, 4, v0
    v_lshl_add_u32 v208, v80, 4, v208
    v_xor_b32 v209, 0x1000, v4
    s_waitcnt vmcnt(1)
    s_cmp_lg_u32 s49, 0
    s_cbranch_scc1 L_ool26
L_back27:
    s_mov_b64 exec, 1
    buffer_store_dword v98, v2, s[4:7], s68 offen
    s_mov_b64 exec, -1
    v_readlane_b32 s76, v79, 18
    v_readlane_b32 s73, v78, 18
    s_mov_b32 m0, s76
    s_nop 3
    buffer_load_dwordx4 v6, s[28:31], s73 offen lds
    v_readlane_b32 s76, v79, 19
    v_readlane_b32 s73, v78, 19
    s_mov_b32 m0, s76
    s_nop 3
    buffer_load_dwordx4 v6, s[28:31], s73 offen lds
    v_readlane_b32 s76, v79, 20
    v_readlane_b32 s73, v78, 20
    s_mov_b32 m0, s76
    s_nop 3
    buffer_load_dwordx4 v6, s[28:31], s73 offen lds
    v_readlane_b32 s76, v79, 21
    v_readlane_b32 s73, v78, 21
    s_mov_b32 m0, s76
    s_nop 3
    buffer_load_dwordx4 v6, s[28:31], s73 offen lds
    v_readlane_b32 s76, v79, 22
    v_readlane_b32 s73, v78, 22
    s_mov_b32 m0, s76
    s_nop 3
    buffer_load_dwordx4 v6, s[28:31], s73 offen lds
    v_readlane_b32 s76, v79, 23
    v_readlane_b32 s73, v78, 23
    s_mov_b32 m0, s76
    s_nop 3
    buffer_load_dwordx4 v6, s[28:31], s73 offen lds
    ds_read_b64_tr_b16 a[64:65], v76 offset:32768
    ds_read_b64_tr_b16 a[66:67], v76 offset:33024
    ds_read_b64_tr_b16 a[68:69], v76 offset:34816
    ds_read_b64_tr_b16 a[70:71], v76 offset:35072
    ds_read_b64_tr_b16 a[72:73], v76 offset:36864
    ds_read_b64_tr_b16 a[74:75], v76 offset:37120
    ds_read_b64_tr_b16 a[76:77], v76 offset:38912
    ds_read_b64_tr_b16 a[78:79], v76 offset:39168
    ds_read_b64_tr_b16 a[80:81], v76 offset:40960
    ds_read_b64_tr_b16 a[82:83], v76 offset:41216
    ds_read_b64_tr_b16 a[84:85], v76 offset:43008
    ds_read_b64_tr_b16 a[86:87], v76 offset:43264
    ds_read_b64_tr_b16 a[88:89], v76 offset:45056
    ds_read_b64_tr_b16 a[90:91], v76 offset:45312
    ds_read_b64_tr_b16 a[92:93], v76 offset:47104
    ds_read_b64_tr_b16 a[94:95], v76 offset:47360
    ds_read_b64_tr_b16 a[96:97], v76 offset:49152
    ds_read_b64_tr_b16 a[98:99], v76 offset:49408
    ds_read_b64_tr_b16 a[100:101], v76 offset:51200
    ds_read_b64_tr_b16 a[102:103], v76 offset:51456
    ds_read_b64_tr_b16 a[104:105], v76 offset:53248
    ds_read_b64_tr_b16 a[106:107], v76 offset:53504
    ds_read_b64_tr_b16 a[108:109], v76 offset:55296
    ds_read_b64_tr_b16 a[110:111], v76 offset:55552
    ds_read_b64_tr_b16 a[112:113], v76 offset:57344
    ds_read_b64_tr_b16 a[114:115], v76 offset:57600
    ds_read_b64_tr_b16 a[116:117], v76 offset:59392
    ds_read_b64_tr_b16 a[118:119], v76 offset:59648
    ds_read_b64_tr_b16 a[120:121], v76 offset:61440
    ds_read_b64_tr_b16 a[122:123], v76 offset:61696
    ds_read_b64_tr_b16 a[124:125], v76 offset:63488
    ds_read_b64_tr_b16 a[126:127], v76 offset:63744
    s_cmp_eq_u32 s49, 0
    s_cselect_b32 s57, 400000, 0
L_pl28:
    buffer_load_dword v42, v40, s[4:7], s71 offen sc1
    s_sub_u32 s57, s57, 1
    s_waitcnt vmcnt(0)
    v_cmp_ne_u32 vcc, s47, v42
    s_cbranch_scc1 L_ps30
    s_cbranch_vccnz L_pl28
L_pe31:
    s_waitcnt lgkmcnt(0)
    s_barrier
    s_mov_b32 m0, s66
    s_nop 0
    buffer_load_dwordx4 v192, s[36:39], m0 offen offset:0 sc1 lds
    buffer_load_dwordx4 v192, s[36:39], m0 offen offset:1024 sc1 lds
    buffer_load_dwordx4 v192, s[36:39], m0 offen offset:2048 sc1 lds
    buffer_load_dwordx4 v192, s[36:39], m0 offen offset:3072 sc1 lds
    buffer_load_dwordx4 v[48:51], v1, s[4:7], s78 offen offset:0 sc1
    buffer_load_dwordx4 v[52:55], v1, s[4:7], s78 offen offset:1024 sc1
    v_mfma_f32_16x16x32_bf16 v[16:19], v[100:103], a[0:3], 0
    s_add_u32 m0, m0, 4096
    ds_read_b64_tr_b16 a[128:129], v77 offset:0
    v_mfma_f32_16x16x32_bf16 v[16:19], v[100:103], a[4:7], v[16:19]
    buffer_load_dwordx4 v192, s[36:39], m0 offen offset:0 sc1 lds
    v_mfma_f32_16x16x32_bf16 v[16:19], v[100:103], a[8:11], v[16:19]
    ds_read_b64_tr_b16 a[130:131], v77 offset:256
    v_mfma_f32_16x16x32_bf16 v[16:19], v[100:103], a[12:15], v[16:19]
    ds_read_b64_tr_b16 a[132:133], v77 offset:2048
    v_mfma_f32_16x16x32_bf16 v[16:19], v[100:103], a[16:19], v[16:19]
    buffer_load_dwordx4 v192, s[36:39], m0 offen offset:1024 sc1 lds
    v_mfma_f32_16x16x32_bf16 v[16:19], v[100:103], a[20:23], v[16:19]
    ds_read_b64_tr_b16 a[134:135], v77 offset:2304
    v_mfma_f32_16x16x32_bf16 v[16:19], v[100:103], a[24:27], v[16:19]
    ds_read_b64_tr_b16 a[136:137], v77 offset:4096
    v_mfma_f32_16x16x32_bf16 v[16:19], v[100:103], a[28:31], v[16:19]
    ds_read_b64_tr_b16 a[138:139], v77 offset:4352
    v_mfma_f32_16x16x32_bf16 v[16:19], v[100:103], a[32:35], v[16:19]
    buffer_load_dwordx4 v192, s[36:39], m0 offen offset:2048 sc1 lds
    v_mfma_f32_16x16x32_bf16 v[16:19], v[100:103], a[36:39], v[16:19]
    ds_read_b64_tr_b16 a[140:141], v77 offset:6144
    v_mfma_f32_16x16x32_bf16 v[16:19], v[100:103], a[40:43], v[16:19]
    ds_read_b64_tr_b16 a[142:143], v77 offset:6400
    v_mfma_f32_16x16x32_bf16 v[16:19], v[100:103], a[44:47], v[16:19]
    ds_read_b64_tr_b16 a[144:145], v77 offset:8192
    v_mfma_f32_16x16x32_bf16 v[16:19], v[100:103], a[48:51], v[16:19]
    buffer_load_dwordx4 v192, s[36:39], m0 offen offset:3072 sc1 lds
    v_mfma_f32_16x16x32_bf16 v[16:19], v[100:103], a[52:55], v[16:19]
    s_add_u32 m0, m0, 12288
    ds_read_b64_tr_b16 a[146:147], v77 offset:8448
    v_mfma_f32_16x16x32_bf16 v[16:19], v[100:103], a[56:59], v[16:19]
    ds_read_b64_tr_b16 a[148:149], v77 offset:10240
    v_mfma_f32_16x16x32_bf16 v[16:19], v[100:103], a[60:63], v[16:19]
    ds_read_b64_tr_b16 a[150:151], v77 offset:10496
    v_mfma_f32_16x16x32_bf16 v[20:23], v[100:103], a[64:67], 0
    buffer_load_dwordx4 v192, s[36:39], m0 offen offset:0 sc1 lds
    v_mfma_f32_16x16x32_bf16 v[20:23], v[100:103], a[68:71], v[20:23]
    ds_read_b64_tr_b16 a[152:153], v77 offset:12288
    v_mfma_f32_16x16x32_bf16 v[20:23], v[100:103], a[72:75], v[20:23]
    ds_read_b64_tr_b16 a[154:155], v77 offset:12544
    v_mfma_f32_16x16x32_bf16 v[20:23], v[100:103], a[76:79], v[20:23]
    ds_read_b64_tr_b16 a[156:157], v77 offset:14336
    v_mfma_f32_16x16x32_bf16 v[20:23], v[100:103], a[80:83], v[20:23]
    buffer_load_dwordx4 v192, s[36:39], m0 offen offset:1024 sc1 lds
    v_mfma_f32_16x16x32_bf16 v[20:23], v[100:103], a[84:87], v[20:23]
    ds_read_b64_tr_b16 a[158:159], v77 offset:14592
    v_mfma_f32_16x16x32_bf16 v[20:23], v[100:103], a[88:91], v[20:23]
    ds_read_b64_tr_b16 a[160:161], v77 offset:16384
    v_mfma_f32_16x16x32_bf16 v[20:23], v[100:103], a[92:95], v[20:23]
    ds_read_b64_tr_b16 a[162:163], v77 offset:16640
    v_mfma_f32_16x16x32_bf16 v[20:23], v[100:103], a[96:99], v[20:23]
    ds_read_b64_tr_b16 a[164:165], v77 offset:18432
    v_mfma_f32_16x16x32_bf16 v[20:23], v[100:103], a[100:103], v[20:23]
    ds_read_b64_tr_b16 a[166:167], v77 offset:18688
    v_mfma_f32_16x16x32_bf16 v[20:23], v[100:103], a[104:107], v[20:23]
    ds_read_b64_tr_b16 a[168:169], v77 offset:20480
    v_mfma_f32_16x16x32_bf16 v[20:23], v[100:103], a[108:111], v[20:23]
    ds_read_b64_tr_b16 a[170:171], v77 offset:20736
    v_mfma_f32_16x16x32_bf16 v[20:23], v[100:103], a[112:115], v[20:23]
    ds_read_b64_tr_b16 a[172:173], v77 offset:22528
    v_mfma_f32_16x16x32_bf16 v[20:23], v[100:103], a[116:119], v[20:23]
    ds_read_b64_tr_b16 a[174:175], v77 offset:22784
    v_mfma_f32_16x16x32_bf16 v[20:23], v[100:103], a[120:123], v[20:23]
    ds_read_b64_tr_b16 a[176:177], v77 offset:24576
    v_mfma_f32_16x16x32_bf16 v[20:23], v[100:103], a[124:127], v[20:23]
    ds_read_b64_tr_b16 a[178:179], v77 offset:24832
    ds_read_b64_tr_b16 a[180:181], v77 offset:26624
    ds_read_b64_tr_b16 a[182:183], v77 offset:26880
    ds_read_b64_tr_b16 a[184:185], v77 offset:28672
    ds_read_b64_tr_b16 a[186:187], v77 offset:28928
    ds_read_b64_tr_b16 a[188:189], v77 offset:30720
    ds_read_b64_tr_b16 a[190:191], v77 offset:30976
    s_waitcnt vmcnt(8)
    s_waitcnt lgkmcnt(0)
    s_barrier
    ds_read_b128 v[24:27], v5 offset:0
    ds_read_b128 v[28:31], v5 offset:1024
    ds_read_b128 v[32:35], v5 offset:2048
    ds_read_b128 v[36:39], v5 offset:3072
    ds_read_b128 v[40:43], v5 offset:8192
    s_waitcnt lgkmcnt(4)
    v_mfma_f32_16x16x32_bf16 v[8:11], v[24:27], a[0:3], 0
    buffer_load_dwordx4 v192, s[36:39], m0 offen offset:2048 sc1 lds
    v_mov_b32 v96, v16
    v_mfma_f32_16x16x32_bf16 v[12:15], v[24:27], a[64:67], 0
    v_mov_b32 v97, v20
    v_mfma_f32_16x16x32_bf16 v[212:215], a[128:131], v[24:27], 0
    ds_read_b128 v[44:47], v5 offset:9216
    s_waitcnt lgkmcnt(4)
    v_mfma_f32_16x16x32_bf16 v[8:11], v[28:31], a[4:7], v[8:11]
    buffer_load_dwordx4 v192, s[36:39], m0 offen offset:3072 sc1 lds
    s_waitcnt vmcnt(9)
    v_bitop3_b32 v56, v48, v49, s70 bitop3:0x96
    v_mfma_f32_16x16x32_bf16 v[12:15], v[28:31], a[68:71], v[12:15]
    s_waitcnt lgkmcnt(2)
    v_bitop3_b32 v57, v50, v51, s70 bitop3:0x96
    s_waitcnt vmcnt(8)
    v_bitop3_b32 v58, v52, v53, s70 bitop3:0x96
    v_mfma_f32_16x16x32_bf16 v[212:215], a[132:135], v[28:31], v[212:215]
    s_add_u32 m0, m0, 4096
    ds_read_b128 v[24:27], v5 offset:10240
    v_bitop3_b32 v59, v54, v55, s70 bitop3:0x96
    v_mfma_f32_16x16x32_bf16 v[8:11], v[32:35], a[8:11], v[8:11]
    v_or3_b32 v56, v56, v57, v58
    v_or_b32 v56, v56, v59
    v_mfma_f32_16x16x32_bf16 v[12:15], v[32:35], a[72:75], v[12:15]
    v_cmp_ne_u32 vcc, 0, v56
    v_mfma_f32_16x16x32_bf16 v[212:215], a[136:139], v[32:35], v[212:215]
    s_cbranch_vccnz L_ool33
L_back34:
    ds_read_b128 v[28:31], v5 offset:11264
    v_add_f32 v48, v48, v52
    v_mfma_f32_16x16x32_bf16 v[8:11], v[36:39], a[12:15], v[8:11]
    buffer_load_dwordx4 v192, s[36:39], m0 offen offset:0 sc1 lds
    v_add_f32 v50, v50, v54
    v_mfma_f32_16x16x32_bf16 v[12:15], v[36:39], a[76:79], v[12:15]
    s_waitcnt lgkmcnt(2)
    v_permlane32_swap_b32 v48, v50
    v_mfma_f32_16x16x32_bf16 v[212:215], a[140:143], v[36:39], v[212:215]
    v_add_f32 v48, v48, v50
    v_mul_f32 v48, s93, v48
    v_mfma_f32_16x16x32_bf16 v[8:11], v[40:43], a[32:35], v[8:11]
    buffer_load_dwordx4 v192, s[36:39], m0 offen offset:1024 sc1 lds
    v_mov_b32 v49, v48
    v_mfma_f32_16x16x32_bf16 v[12:15], v[40:43], a[96:99], v[12:15]
    s_nop 0
    v_permlane32_swap_b32 v48, v49
    v_mfma_f32_16x16x32_bf16 v[212:215], a[160:163], v[40:43], v[212:215]
    v_fma_f32 v49, -v48, v48, v49
    v_cvt_pk_bf16_f32 v48, v48, v48
    v_mfma_f32_16x16x32_bf16 v[8:11], v[44:47], a[36:39], v[8:11]
    v_max_f32 v49, 0, v49
    v_add_f32 v49, s94, v49
    v_mfma_f32_16x16x32_bf16 v[12:15], v[44:47], a[100:103], v[12:15]
    s_waitcnt lgkmcnt(0)
    v_rsq_f32 v49, v49
    v_mfma_f32_16x16x32_bf16 v[212:215], a[164:167], v[44:47], v[212:215]
    s_waitcnt vmcnt(6)
    s_barrier
    ds_read_b128 v[32:35], v5 offset:4096
    v_and_b32 v48, s90, v48
    v_mfma_f32_16x16x32_bf16 v[8:11], v[24:27], a[40:43], v[8:11]
    buffer_load_dwordx4 v192, s[36:39], m0 offen offset:2048 sc1 lds
    v_mul_f32 v49, s95, v49
    v_mfma_f32_16x16x32_bf16 v[12:15], v[24:27], a[104:107], v[12:15]
    ds_read_b128 v[36:39], v5 offset:5120
    v_cmp_gt_u32 vcc, 32, v0
    v_mfma_f32_16x16x32_bf16 v[212:215], a[168:171], v[24:27], v[212:215]
    ds_read_b128 v[40:43], v5 offset:6144
    v_mfma_f32_16x16x32_bf16 v[8:11], v[28:31], a[44:47], v[8:11]
    buffer_load_dwordx4 v192, s[36:39], m0 offen offset:3072 sc1 lds
    v_cndmask_b32 v48, v49, v48, vcc
    v_mfma_f32_16x16x32_bf16 v[12:15], v[28:31], a[108:111], v[12:15]
    s_waitcnt lgkmcnt(1)
    ds_read_b128 v[44:47], v5 offset:7168
    v_mfma_f32_16x16x32_bf16 v[212:215], a[172:175], v[28:31], v[212:215]
    s_add_u32 m0, m0, 12288
    ds_read_b128 v[24:27], v5 offset:12288
    v_mfma_f32_16x16x32_bf16 v[8:11], v[32:35], a[16:19], v[8:11]
    ds_write_b32 v194, v48
    v_bfe_u32 v195, v0, 2, 2
    v_mfma_f32_16x16x32_bf16 v[12:15], v[32:35], a[80:83], v[12:15]
    v_lshlrev_b32 v60, 2, v195
    v_mfma_f32_16x16x32_bf16 v[212:215], a[144:147], v[32:35], v[212:215]
    s_lshl_b32 s58, s46, 2
    ds_read_b128 v[28:31], v5 offset:13312
    v_xor_b32 v60, s58, v60
    v_mfma_f32_16x16x32_bf16 v[8:11], v[36:39], a[20:23], v[8:11]
    buffer_load_dwordx4 v192, s[36:39], m0 offen offset:0 sc1 lds
    v_and_b32 v195, 3, v0
    v_mfma_f32_16x16x32_bf16 v[12:15], v[36:39], a[84:87], v[12:15]
    s_waitcnt lgkmcnt(3)
    v_or_b32 v60, v60, v195
    v_lshrrev_b32 v195, 2, v0
    v_mfma_f32_16x16x32_bf16 v[212:215], a[148:151], v[36:39], v[212:215]
    ds_read_b128 v[32:35], v5 offset:14336
    v_lshlrev_b32 v195, 8, v195
    v_mfma_f32_16x16x32_bf16 v[8:11], v[40:43], a[24:27], v[8:11]
    buffer_load_dwordx4 v192, s[36:39], m0 offen offset:1024 sc1 lds
    v_lshl_add_u32 v195, v60, 4, v195
    v_mfma_f32_16x16x32_bf16 v[12:15], v[40:43], a[88:91], v[12:15]
    v_add_u32 v196, 0x10000, v195
    v_mfma_f32_16x16x32_bf16 v[212:215], a[152:155], v[40:43], v[212:215]
    s_lshr_b32 s40, s46, 1
    ds_read_b128 v[36:39], v5 offset:15360
    v_mfma_f32_16x16x32_bf16 v[8:11], v[44:47], a[28:31], v[8:11]
    s_lshl_b32 s40, s40, 16
    v_mfma_f32_16x16x32_bf16 v[12:15], v[44:47], a[92:95], v[12:15]
    s_waitcnt lgkmcnt(2)
    v_mfma_f32_16x16x32_bf16 v[212:215], a[156:159], v[44:47], v[212:215]
    buffer_load_dwordx4 v192, s[36:39], m0 offen offset:2048 sc1 lds
    buffer_load_dwordx4 v192, s[36:39], m0 offen offset:3072 sc1 lds
    s_add_u32 m0, m0, 4096
    s_nop 0
    buffer_load_dwordx4 v192, s[36:39], m0 offen offset:0 sc1 lds
    buffer_load_dwordx4 v192, s[36:39], m0 offen offset:1024 sc1 lds
    s_waitcnt vmcnt(6)
    s_barrier
    s_and_b32 s41, s46, 1
    ds_read_b128 v[40:43], v5 offset:16384
    v_mfma_f32_16x16x32_bf16 v[8:11], v[24:27], a[48:51], v[8:11]
    s_lshl_b32 s41, s41, 14
    buffer_load_dwordx4 v192, s[36:39], m0 offen offset:2048 sc1 lds
    v_mfma_f32_16x16x32_bf16 v[12:15], v[24:27], a[112:115], v[12:15]
    s_add_u32 s40, s40, s41
    v_mfma_f32_16x16x32_bf16 v[212:215], a[176:179], v[24:27], v[212:215]
    s_lshl_b32 s41, s46, 15
    ds_read_b128 v[44:47], v5 offset:17408
    v_mfma_f32_16x16x32_bf16 v[8:11], v[28:31], a[52:55], v[8:11]
    s_lshl_b32 s58, s51, 8
    buffer_load_dwordx4 v192, s[36:39], m0 offen offset:3072 sc1 lds
    v_mfma_f32_16x16x32_bf16 v[12:15], v[28:31], a[116:119], v[12:15]
    s_waitcnt lgkmcnt(2)
    v_mfma_f32_16x16x32_bf16 v[212:215], a[180:183], v[28:31], v[212:215]
    s_add_u32 m0, m0, 12288
    ds_read_b128 v[24:27], v5 offset:18432
    v_mfma_f32_16x16x32_bf16 v[8:11], v[32:35], a[56:59], v[8:11]
    s_add_u32 s41, s41, s58
    ds_read_b128 v[48:51], v198 offset:0
    v_mfma_f32_16x16x32_bf16 v[12:15], v[32:35], a[120:123], v[12:15]
    ds_read_b128 v[52:55], v198 offset:512
    v_mfma_f32_16x16x32_bf16 v[212:215], a[184:187], v[32:35], v[212:215]
    ds_read_b128 v[28:31], v5 offset:19456
    v_mfma_f32_16x16x32_bf16 v[8:11], v[36:39], a[60:63], v[8:11]
    buffer_load_dwordx4 v192, s[36:39], m0 offen offset:0 sc1 lds
    v_mfma_f32_16x16x32_bf16 v[12:15], v[36:39], a[124:127], v[12:15]
    s_waitcnt lgkmcnt(4)
    ds_read_b32 v228, v193 offset:0
    v_mfma_f32_16x16x32_bf16 v[212:215], a[188:191], v[36:39], v[212:215]
    ds_read_b128 v[32:35], v5 offset:24576
    ds_read_b32 v229, v193 offset:512
    ds_read_b32 v230, v193 offset:64
    ds_read_b32 v231, v193 offset:576
    ds_read_b32 v232, v193 offset:128
    ds_read_b32 v233, v193 offset:640
    ds_read_b32 v234, v193 offset:192
    ds_read_b32 v235, v193 offset:704
    v_mfma_f32_16x16x32_bf16 v[16:19], v[40:43], a[0:3], 0
    buffer_load_dwordx4 v192, s[36:39], m0 offen offset:1024 sc1 lds
    v_mfma_f32_16x16x32_bf16 v[20:23], v[40:43], a[64:67], 0
    v_mfma_f32_16x16x32_bf16 v[216:219], a[128:131], v[40:43], 0
    ds_read_b128 v[36:39], v5 offset:25600
    s_waitcnt lgkmcnt(12)
    v_fma_f32 v8, -v48, v96, v8
    v_mfma_f32_16x16x32_bf16 v[16:19], v[44:47], a[4:7], v[16:19]
    v_fma_f32 v9, -v49, v96, v9
    v_fma_f32 v10, -v50, v96, v10
    v_mfma_f32_16x16x32_bf16 v[20:23], v[44:47], a[68:71], v[20:23]
    s_waitcnt lgkmcnt(10)
    v_fma_f32 v11, -v51, v96, v11
    v_fma_f32 v12, -v48, v97, v12
    v_mfma_f32_16x16x32_bf16 v[216:219], a[132:135], v[44:47], v[216:219]
    ds_read_b128 v[40:43], v5 offset:26624
    v_fma_f32 v13, -v49, v97, v13
    v_mfma_f32_16x16x32_bf16 v[16:19], v[24:27], a[8:11], v[16:19]
    buffer_load_dwordx4 v192, s[36:39], m0 offen offset:2048 sc1 lds
    v_fma_f32 v14, -v50, v97, v14
    v_mfma_f32_16x16x32_bf16 v[20:23], v[24:27], a[72:75], v[20:23]
    v_fma_f32 v15, -v51, v97, v15
    v_mul_f32 v8, v8, v52
    v_mfma_f32_16x16x32_bf16 v[216:219], a[136:139], v[24:27], v[216:219]
    ds_read_b128 v[44:47], v5 offset:27648
    v_mul_f32 v9, v9, v53
    v_mfma_f32_16x16x32_bf16 v[16:19], v[28:31], a[12:15], v[16:19]
    buffer_load_dwordx4 v192, s[36:39], m0 offen offset:3072 sc1 lds
    v_mul_f32 v10, v10, v54
    v_mfma_f32_16x16x32_bf16 v[20:23], v[28:31], a[76:79], v[20:23]
    s_waitcnt lgkmcnt(2)
    v_mul_f32 v11, v11, v55
    v_mfma_f32_16x16x32_bf16 v[216:219], a[140:143], v[28:31], v[216:219]
    s_add_u32 m0, m0, 4096
    ds_read_b128 v[24:27], v5 offset:20480
    v_mfma_f32_16x16x32_bf16 v[16:19], v[32:35], a[32:35], v[16:19]
    v_exp_f32 v56, v8 clamp
    v_mfma_f32_16x16x32_bf16 v[20:23], v[32:35], a[96:99], v[20:23]
    v_mul_f32 v12, v12, v52
    v_mfma_f32_16x16x32_bf16 v[216:219], a[160:163], v[32:35], v[216:219]
    ds_read_b128 v[28:31], v5 offset:21504
    v_mfma_f32_16x16x32_bf16 v[16:19], v[36:39], a[36:39], v[16:19]
    buffer_load_dwordx4 v192, s[36:39], m0 offen offset:0 sc1 lds
    v_mfma_f32_16x16x32_bf16 v[20:23], v[36:39], a[100:103], v[20:23]
    s_waitcnt lgkmcnt(2)
    v_exp_f32 v57, v9 clamp
    v_mfma_f32_16x16x32_bf16 v[216:219], a[164:167], v[36:39], v[216:219]
    ds_read_b128 v[32:35], v5 offset:22528
    v_mul_f32 v13, v13, v53
    v_mfma_f32_16x16x32_bf16 v[16:19], v[40:43], a[40:43], v[16:19]
    buffer_load_dwordx4 v192, s[36:39], m0 offen offset:1024 sc1 lds
    v_mfma_f32_16x16x32_bf16 v[20:23], v[40:43], a[104:107], v[20:23]
    v_exp_f32 v58, v10 clamp
    v_mfma_f32_16x16x32_bf16 v[216:219], a[168:171], v[40:43], v[216:219]
    ds_read_b128 v[36:39], v5 offset:23552
    v_mul_f32 v14, v14, v54
    v_mfma_f32_16x16x32_bf16 v[16:19], v[44:47], a[44:47], v[16:19]
    v_exp_f32 v59, v11 clamp
    v_mfma_f32_16x16x32_bf16 v[20:23], v[44:47], a[108:111], v[20:23]
    s_waitcnt lgkmcnt(2)
    v_mul_f32 v15, v15, v55
    v_fma_f32 v8, v8, v84, s91
    v_mfma_f32_16x16x32_bf16 v[216:219], a[172:175], v[44:47], v[216:219]
    ds_read_b128 v[40:43], v5 offset:28672
    v_fma_f32 v9, v9, v84, s91
    v_mfma_f32_16x16x32_bf16 v[16:19], v[24:27], a[16:19], v[16:19]
    buffer_load_dwordx4 v192, s[36:39], m0 offen offset:2048 sc1 lds
    v_fma_f32 v10, v10, v84, s91
    v_mfma_f32_16x16x32_bf16 v[20:23], v[24:27], a[80:83], v[20:23]
    v_fma_f32 v11, v11, v84, s91
    v_mfma_f32_16x16x32_bf16 v[216:219], a[144:147], v[24:27], v[216:219]
    ds_read_b128 v[44:47], v5 offset:29696
    v_mfma_f32_16x16x32_bf16 v[16:19], v[28:31], a[20:23], v[16:19]
    buffer_load_dwordx4 v192, s[36:39], m0 offen offset:3072 sc1 lds
    v_mfma_f32_16x16x32_bf16 v[20:23], v[28:31], a[84:87], v[20:23]
    s_waitcnt lgkmcnt(2)
    ds_read_b128 v[48:51], v198 offset:64
    v_add_f32 v56, s92, v56
    v_mfma_f32_16x16x32_bf16 v[216:219], a[148:151], v[28:31], v[216:219]
    ds_read_b128 v[24:27], v5 offset:30720
    v_add_f32 v57, s92, v57
    v_mfma_f32_16x16x32_bf16 v[16:19], v[32:35], a[24:27], v[16:19]
    v_add_f32 v58, s92, v58
    v_add_f32 v59, s92, v59
    v_mfma_f32_16x16x32_bf16 v[20:23], v[32:35], a[88:91], v[20:23]
    ds_read_b128 v[52:55], v198 offset:576
    v_max_f32 v8, v8, v56
    v_mfma_f32_16x16x32_bf16 v[216:219], a[152:155], v[32:35], v[216:219]
    ds_read_b128 v[28:31], v5 offset:31744
    v_max_f32 v9, v9, v57
    v_mfma_f32_16x16x32_bf16 v[16:19], v[36:39], a[28:31], v[16:19]
    v_and_b32 v129, 31, v0
    v_lshlrev_b32 v129, 7, v129
    v_mfma_f32_16x16x32_bf16 v[20:23], v[36:39], a[92:95], v[20:23]
    s_waitcnt lgkmcnt(4)
    v_max_f32 v10, v10, v58
    v_max_f32 v11, v11, v59
    v_mfma_f32_16x16x32_bf16 v[216:219], a[156:159], v[36:39], v[216:219]
    s_lshl_b32 s58, s45, 14
    s_lshl_b32 s59, s46, 12
    s_add_u32 s58, s58, s59
    buffer_load_dword v128, v129, s[32:35], s58 offen
    s_waitcnt vmcnt(9)
    s_barrier
    ds_read_b128 v[32:35], v5 offset:32768
    v_cvt_pk_bf16_f32 v64, v12, v13
    v_mfma_f32_16x16x32_bf16 v[16:19], v[40:43], a[48:51], v[16:19]
    v_cvt_pk_bf16_f32 v65, v14, v15
    v_cvt_pk_bf16_f32 v60, v8, v9
    v_mfma_f32_16x16x32_bf16 v[20:23], v[40:43], a[112:115], v[20:23]
    v_cvt_pk_bf16_f32 v61, v10, v11
    v_mfma_f32_16x16x32_bf16 v[216:219], a[176:179], v[40:43], v[216:219]
    ds_read_b128 v[36:39], v5 offset:33792
    v_mfma_f32_16x16x32_bf16 v[16:19], v[44:47], a[52:55], v[16:19]
    v_mfma_f32_16x16x32_bf16 v[20:23], v[44:47], a[116:119], v[20:23]
    s_waitcnt lgkmcnt(2)
    v_mfma_f32_16x16x32_bf16 v[216:219], a[180:183], v[44:47], v[216:219]
    ds_read_b128 v[40:43], v5 offset:34816
    v_mfma_f32_16x16x32_bf16 v[16:19], v[24:27], a[56:59], v[16:19]
    v_mfma_f32_16x16x32_bf16 v[20:23], v[24:27], a[120:123], v[20:23]
    v_mfma_f32_16x16x32_bf16 v[216:219], a[184:187], v[24:27], v[216:219]
    ds_read_b128 v[44:47], v5 offset:35840
    v_mfma_f32_16x16x32_bf16 v[16:19], v[28:31], a[60:63], v[16:19]
    v_mfma_f32_16x16x32_bf16 v[20:23], v[28:31], a[124:127], v[20:23]
    s_waitcnt lgkmcnt(2)
    v_mfma_f32_16x16x32_bf16 v[216:219], a[188:191], v[28:31], v[216:219]
    ds_read_b128 v[24:27], v5 offset:40960
    v_mfma_f32_16x16x32_bf16 v[8:11], v[32:35], a[0:3], 0
    v_mfma_f32_16x16x32_bf16 v[12:15], v[32:35], a[64:67], 0
    ds_read_b128 v[28:31], v5 offset:41984
    v_mfma_f32_16x16x32_bf16 v[8:11], v[36:39], a[4:7], v[8:11]
    s_waitcnt lgkmcnt(2)
    v_fma_f32 v16, -v48, v96, v16
    v_fma_f32 v17, -v49, v96, v17
    v_mfma_f32_16x16x32_bf16 v[12:15], v[36:39], a[68:71], v[12:15]
    ds_read_b128 v[32:35], v5 offset:43008
    v_fma_f32 v18, -v50, v96, v18
    v_mfma_f32_16x16x32_bf16 v[8:11], v[40:43], a[8:11], v[8:11]
    v_fma_f32 v19, -v51, v96, v19
    v_fma_f32 v20, -v48, v97, v20
    v_mfma_f32_16x16x32_bf16 v[12:15], v[40:43], a[72:75], v[12:15]
    ds_read_b128 v[36:39], v5 offset:44032
    v_fma_f32 v21, -v49, v97, v21
    v_mfma_f32_16x16x32_bf16 v[8:11], v[44:47], a[12:15], v[8:11]
    s_waitcnt lgkmcnt(2)
    v_fma_f32 v22, -v50, v97, v22
    v_fma_f32 v23, -v51, v97, v23
    v_mfma_f32_16x16x32_bf16 v[12:15], v[44:47], a[76:79], v[12:15]
    ds_read_b128 v[40:43], v5 offset:36864
    v_mul_f32 v16, v16, v52
    v_mfma_f32_16x16x32_bf16 v[8:11], v[24:27], a[32:35], v[8:11]
    v_mul_f32 v17, v17, v53
    v_mul_f32 v18, v18, v54
    v_mfma_f32_16x16x32_bf16 v[12:15], v[24:27], a[96:99], v[12:15]
    ds_read_b128 v[44:47], v5 offset:37888
    v_mul_f32 v19, v19, v55
    v_mfma_f32_16x16x32_bf16 v[8:11], v[28:31], a[36:39], v[8:11]
    s_waitcnt lgkmcnt(2)
    v_exp_f32 v56, v16 clamp
    v_mfma_f32_16x16x32_bf16 v[12:15], v[28:31], a[100:103], v[12:15]
    ds_read_b128 v[24:27], v5 offset:38912
    v_mul_f32 v20, v20, v52
    v_mfma_f32_16x16x32_bf16 v[8:11], v[32:35], a[40:43], v[8:11]
    v_exp_f32 v57, v17 clamp
    v_mfma_f32_16x16x32_bf16 v[12:15], v[32:35], a[104:107], v[12:15]
    ds_read_b128 v[28:31], v5 offset:39936
    v_mul_f32 v21, v21, v53
    v_mfma_f32_16x16x32_bf16 v[8:11], v[36:39], a[44:47], v[8:11]
    s_waitcnt lgkmcnt(2)
    v_exp_f32 v58, v18 clamp
    v_mfma_f32_16x16x32_bf16 v[12:15], v[36:39], a[108:111], v[12:15]
    ds_read_b128 v[32:35], v5 offset:45056
    v_mul_f32 v22, v22, v54
    v_mfma_f32_16x16x32_bf16 v[8:11], v[40:43], a[16:19], v[8:11]
    v_exp_f32 v59, v19 clamp
    v_mfma_f32_16x16x32_bf16 v[12:15], v[40:43], a[80:83], v[12:15]
    ds_read_b128 v[36:39], v5 offset:46080
    v_mul_f32 v23, v23, v55
    v_mfma_f32_16x16x32_bf16 v[8:11], v[44:47], a[20:23], v[8:11]
    s_waitcnt lgkmcnt(2)
    v_fma_f32 v16, v16, v84, s91
    v_fma_f32 v17, v17, v84, s91
    v_mfma_f32_16x16x32_bf16 v[12:15], v[44:47], a[84:87], v[12:15]
    ds_read_b128 v[40:43], v5 offset:47104
    v_fma_f32 v18, v18, v84, s91
    v_mfma_f32_16x16x32_bf16 v[8:11], v[24:27], a[24:27], v[8:11]
    v_fma_f32 v19, v19, v84, s91
    v_mfma_f32_16x16x32_bf16 v[12:15], v[24:27], a[88:91], v[12:15]
    ds_read_b128 v[44:47], v5 offset:48128
    v_mfma_f32_16x16x32_bf16 v[8:11], v[28:31], a[28:31], v[8:11]
    s_waitcnt lgkmcnt(2)
    ds_read_b128 v[48:51], v198 offset:128
    v_add_f32 v56, s92, v56
    v_mfma_f32_16x16x32_bf16 v[12:15], v[28:31], a[92:95], v[12:15]
    s_waitcnt vmcnt(1)
    s_barrier
    ds_read_b128 v[24:27], v5 offset:49152
    v_add_f32 v57, s92, v57
    v_mfma_f32_16x16x32_bf16 v[8:11], v[32:35], a[48:51], v[8:11]
    s_add_u32 m0, s40, 0
    v_add_f32 v58, s92, v58
    v_add_f32 v59, s92, v59
    v_mfma_f32_16x16x32_bf16 v[12:15], v[32:35], a[112:115], v[12:15]
    s_add_u32 s73, s41, 0
    ds_read_b128 v[28:31], v5 offset:50176
    v_mfma_f32_16x16x32_bf16 v[8:11], v[36:39], a[52:55], v[8:11]
    s_waitcnt lgkmcnt(3)
    buffer_load_dwordx4 v86, s[32:35], s73 offen lds
    v_mfma_f32_16x16x32_bf16 v[12:15], v[36:39], a[116:119], v[12:15]
    ds_read_b128 v[32:35], v5 offset:51200
    v_mfma_f32_16x16x32_bf16 v[8:11], v[40:43], a[56:59], v[8:11]
    s_add_u32 m0, m0, 1024
    ds_read_b128 v[52:55], v198 offset:640
    v_max_f32 v16, v16, v56
    v_mfma_f32_16x16x32_bf16 v[12:15], v[40:43], a[120:123], v[12:15]
    s_add_u32 s73, s73, 4096
    ds_read_b128 v[36:39], v5 offset:52224
    v_max_f32 v17, v17, v57
    v_mfma_f32_16x16x32_bf16 v[8:11], v[44:47], a[60:63], v[8:11]
    s_waitcnt lgkmcnt(3)
    buffer_load_dwordx4 v86, s[32:35], s73 offen lds
    v_max_f32 v18, v18, v58
    v_mfma_f32_16x16x32_bf16 v[12:15], v[44:47], a[124:127], v[12:15]
    ds_read_b128 v[40:43], v5 offset:57344
    v_max_f32 v19, v19, v59
    v_cvt_pk_bf16_f32 v66, v20, v21
    v_cvt_pk_bf16_f32 v67, v22, v23
    v_cvt_pk_bf16_f32 v62, v16, v17
    v_cvt_pk_bf16_f32 v63, v18, v19
    s_nop 1
    v_mfma_f32_16x16x32_bf16 v[68:71], v[60:63], v[64:67], 0
    v_mfma_f32_16x16x32_bf16 v[72:75], v[60:63], v[100:103], 0
    v_mfma_f32_16x16x32_bf16 v[16:19], v[24:27], a[0:3], 0
    s_add_u32 m0, m0, 1024
    v_mfma_f32_16x16x32_bf16 v[20:23], v[24:27], a[64:67], 0
    s_add_u32 s73, s73, 4096
    ds_read_b128 v[44:47], v5 offset:58368
    v_mfma_f32_16x16x32_bf16 v[16:19], v[28:31], a[4:7], v[16:19]
    s_waitcnt lgkmcnt(2)
    buffer_load_dwordx4 v86, s[32:35], s73 offen lds
    v_fma_f32 v8, -v48, v96, v8
    v_mfma_f32_16x16x32_bf16 v[20:23], v[28:31], a[68:71], v[20:23]
    s_lshl_b32 s80, s53, 1
    ds_read_b128 v[24:27], v5 offset:59392
    v_fma_f32 v9, -v49, v96, v9
    v_mfma_f32_16x16x32_bf16 v[16:19], v[32:35], a[8:11], v[16:19]
    s_add_u32 m0, m0, 1024
    v_fma_f32 v10, -v50, v96, v10
    v_fma_f32 v11, -v51, v96, v11
    v_mfma_f32_16x16x32_bf16 v[20:23], v[32:35], a[72:75], v[20:23]
    s_add_u32 s73, s73, 4096
    ds_read_b128 v[28:31], v5 offset:60416
    v_fma_f32 v12, -v48, v97, v12
    v_mfma_f32_16x16x32_bf16 v[16:19], v[36:39], a[12:15], v[16:19]
    s_waitcnt lgkmcnt(2)
    buffer_load_dwordx4 v86, s[32:35], s73 offen lds
    v_fma_f32 v13, -v49, v97, v13
    v_mfma_f32_16x16x32_bf16 v[20:23], v[36:39], a[76:79], v[20:23]
    s_and_b32 s81, s46, 1
    ds_read_b128 v[32:35], v5 offset:53248
    v_fma_f32 v14, -v50, v97, v14
    v_mfma_f32_16x16x32_bf16 v[16:19], v[40:43], a[32:35], v[16:19]
    s_add_u32 m0, m0, 1024
    v_fma_f32 v15, -v51, v97, v15
    v_mul_f32 v8, v8, v52
    v_mfma_f32_16x16x32_bf16 v[20:23], v[40:43], a[96:99], v[20:23]
    s_add_u32 s73, s73, 4096
    ds_read_b128 v[36:39], v5 offset:54272
    v_mul_f32 v9, v9, v53
    v_mfma_f32_16x16x32_bf16 v[16:19], v[44:47], a[36:39], v[16:19]
    s_waitcnt lgkmcnt(2)
    buffer_load_dwordx4 v86, s[32:35], s73 offen lds
    v_mul_f32 v10, v10, v54
    v_mfma_f32_16x16x32_bf16 v[20:23], v[44:47], a[100:103], v[20:23]
    s_add_u32 s66, s80, s81
    ds_read_b128 v[40:43], v5 offset:55296
    v_mul_f32 v11, v11, v55
    v_mfma_f32_16x16x32_bf16 v[16:19], v[24:27], a[40:43], v[16:19]
    s_add_u32 m0, m0, 1024
    v_exp_f32 v56, v8 clamp
    v_mfma_f32_16x16x32_bf16 v[20:23], v[24:27], a[104:107], v[20:23]
    s_add_u32 s73, s73, 4096
    ds_read_b128 v[44:47], v5 offset:56320
    v_mul_f32 v12, v12, v52
    v_mfma_f32_16x16x32_bf16 v[16:19], v[28:31], a[44:47], v[16:19]
    s_waitcnt lgkmcnt(2)
    buffer_load_dwordx4 v86, s[32:35], s73 offen lds
    v_mfma_f32_16x16x32_bf16 v[20:23], v[28:31], a[108:111], v[20:23]
    s_lshl_b32 s80, s66, 4
    ds_read_b128 v[24:27], v5 offset:61440
    v_mfma_f32_16x16x32_bf16 v[16:19], v[32:35], a[16:19], v[16:19]
    s_add_u32 m0, m0, 1024
    v_exp_f32 v57, v9 clamp
    v_mfma_f32_16x16x32_bf16 v[20:23], v[32:35], a[80:83], v[20:23]
    s_add_u32 s73, s73, 4096
    ds_read_b128 v[28:31], v5 offset:62464
    v_mul_f32 v13, v13, v53
    v_mfma_f32_16x16x32_bf16 v[16:19], v[36:39], a[20:23], v[16:19]
    s_waitcnt lgkmcnt(2)
    buffer_load_dwordx4 v86, s[32:35], s73 offen lds
    v_mfma_f32_16x16x32_bf16 v[20:23], v[36:39], a[84:87], v[20:23]
    s_add_u32 s80, s80, s52
    ds_read_b128 v[32:35], v5 offset:63488
    v_mfma_f32_16x16x32_bf16 v[16:19], v[40:43], a[24:27], v[16:19]
    s_add_u32 m0, m0, 1024
    v_exp_f32 v58, v10 clamp
    v_mfma_f32_16x16x32_bf16 v[20:23], v[40:43], a[88:91], v[20:23]
    s_add_u32 s73, s73, 4096
    ds_read_b128 v[36:39], v5 offset:64512
    v_mul_f32 v14, v14, v54
    v_mfma_f32_16x16x32_bf16 v[16:19], v[44:47], a[28:31], v[16:19]
    s_waitcnt lgkmcnt(2)
    buffer_load_dwordx4 v86, s[32:35], s73 offen lds
    v_mfma_f32_16x16x32_bf16 v[20:23], v[44:47], a[92:95], v[20:23]
    s_lshl_b32 s64, s80, 9
    ds_read_b128 v[40:43], v5 offset:32768
    v_mfma_f32_16x16x32_bf16 v[16:19], v[24:27], a[48:51], v[16:19]
    s_add_u32 m0, s40, 8192
    v_exp_f32 v59, v11 clamp
    v_mfma_f32_16x16x32_bf16 v[20:23], v[24:27], a[112:115], v[20:23]
    s_add_u32 s73, s41, 131072
    ds_read_b128 v[44:47], v5 offset:33792
    v_mul_f32 v15, v15, v55
    v_mfma_f32_16x16x32_bf16 v[16:19], v[28:31], a[52:55], v[16:19]
    s_waitcnt lgkmcnt(2)
    buffer_load_dwordx4 v86, s[32:35], s73 offen lds
    v_fma_f32 v8, v8, v84, s91
    v_mfma_f32_16x16x32_bf16 v[20:23], v[28:31], a[116:119], v[20:23]
    s_add_u32 s64, s64, 262144
    ds_read_b128 v[24:27], v5 offset:34816
    v_fma_f32 v9, v9, v84, s91
    v_mfma_f32_16x16x32_bf16 v[16:19], v[32:35], a[56:59], v[16:19]
    s_add_u32 m0, m0, 1024
    v_fma_f32 v10, v10, v84, s91
    v_fma_f32 v11, v11, v84, s91
    v_mfma_f32_16x16x32_bf16 v[20:23], v[32:35], a[120:123], v[20:23]
    s_add_u32 s73, s73, 4096
    ds_read_b128 v[28:31], v5 offset:35840
    v_mfma_f32_16x16x32_bf16 v[16:19], v[36:39], a[60:63], v[16:19]
    s_lshl_b32 s65, s80, 6
    buffer_load_dwordx4 v86, s[32:35], s73 offen lds
    v_mfma_f32_16x16x32_bf16 v[20:23], v[36:39], a[124:127], v[20:23]
    s_add_u32 s65, s65, 524288
    ds_read_b128 v[32:35], v5 offset:40960
    ds_read_b128 v[48:51], v198 offset:192
    v_add_f32 v56, s92, v56
    v_add_f32 v57, s92, v57
    v_add_f32 v58, s92, v58
    v_add_f32 v59, s92, v59
    ds_read_b128 v[52:55], v198 offset:704
    v_max_f32 v8, v8, v56
    v_max_f32 v9, v9, v57
    v_max_f32 v10, v10, v58
    v_max_f32 v11, v11, v59
    v_cvt_pk_bf16_f32 v64, v12, v13
    v_cvt_pk_bf16_f32 v65, v14, v15
    v_cvt_pk_bf16_f32 v60, v8, v9
    v_cvt_pk_bf16_f32 v61, v10, v11
    s_cmp_lt_u32 s46, 2
    s_cselect_b32 s64, s64, 0x40000000
    s_cselect_b32 s65, 0x40000000, s65
    s_cselect_b64 vcc, -1, 0
    s_waitcnt lgkmcnt(1)
    v_pk_fma_f32 v[16:17], v[48:49], v[96:97], v[16:17] op_sel_hi:[1,0,1] neg_lo:[1,0,0] neg_hi:[1,0,0]
    v_pk_fma_f32 v[18:19], v[50:51], v[96:97], v[18:19] op_sel_hi:[1,0,1] neg_lo:[1,0,0] neg_hi:[1,0,0]
    s_waitcnt lgkmcnt(0)
    v_pk_mul_f32 v[16:17], v[16:17], v[52:53]
    v_pk_mul_f32 v[18:19], v[18:19], v[54:55]
    v_exp_f32 v56, v16 clamp
    v_exp_f32 v57, v17 clamp
    v_exp_f32 v58, v18 clamp
    v_exp_f32 v59, v19 clamp
    v_pk_fma_f32 v[20:21], v[48:49], v[96:97], v[20:21] op_sel:[0,1,0] op_sel_hi:[1,1,1] neg_lo:[1,0,0] neg_hi:[1,0,0]
    v_pk_fma_f32 v[22:23], v[50:51], v[96:97], v[22:23] op_sel:[0,1,0] op_sel_hi:[1,1,1] neg_lo:[1,0,0] neg_hi:[1,0,0]
    v_pk_mul_f32 v[20:21], v[20:21], v[52:53]
    v_pk_mul_f32 v[22:23], v[22:23], v[54:55]
    v_pk_fma_f32 v[16:17], v[16:17], v[84:85], v[84:85] op_sel:[0,0,1] op_sel_hi:[1,0,1]
    v_pk_fma_f32 v[18:19], v[18:19], v[84:85], v[84:85] op_sel:[0,0,1] op_sel_hi:[1,0,1]
    v_pk_add_f32 v[56:57], v[56:57], s[92:93] op_sel_hi:[1,0]
    v_pk_add_f32 v[58:59], v[58:59], s[92:93] op_sel_hi:[1,0]
    v_max_f32 v16, v16, v56
    v_max_f32 v17, v17, v57
    v_max_f32 v18, v18, v58
    v_max_f32 v19, v19, v59
    v_cvt_pk_bf16_f32 v66, v20, v21
    v_cvt_pk_bf16_f32 v67, v22, v23
    v_cvt_pk_bf16_f32 v62, v16, v17
    v_cvt_pk_bf16_f32 v63, v18, v19
    s_nop 1
    v_mfma_f32_16x16x32_bf16 v[68:71], v[60:63], v[64:67], v[68:71]
    v_mfma_f32_16x16x32_bf16 v[72:75], v[60:63], v[100:103], v[72:75]
    s_nop 7
    v_cndmask_b32 v8, v68, v72, vcc
    v_cndmask_b32 v9, v69, v73, vcc
    v_cndmask_b32 v10, v70, v74, vcc
    v_cndmask_b32 v11, v71, v75, vcc
    ds_write_b128 v4, v[8:11]
    v_cndmask_b32 v68, v72, v68, vcc
    v_cndmask_b32 v69, v73, v69, vcc
    v_cndmask_b32 v70, v74, v70, vcc
    v_cndmask_b32 v71, v75, v71, vcc
    s_waitcnt lgkmcnt(0)
    s_barrier
    ds_read_b128 v[12:15], v209
    s_waitcnt lgkmcnt(0)
    v_pk_add_f32 v[68:69], v[68:69], v[12:13]
    v_pk_add_f32 v[70:71], v[70:71], v[14:15]
    buffer_store_dwordx4 v[68:71], v211, s[4:7], s65 offen sc1
    v_pk_mul_f32 v[8:9], v[68:69], v[84:85] op_sel_hi:[1,0]
    v_pk_mul_f32 v[10:11], v[70:71], v[84:85] op_sel_hi:[1,0]
    v_cvt_pk_bf16_f32 v64, v8, v9
    v_cvt_pk_bf16_f32 v65, v10, v11
    buffer_store_dwordx2 v[64:65], v83, s[4:7], s64 offen sc1
    s_cmp_lg_u32 s49, 0
    s_cbranch_scc1 L_ool35
L_back36:
    s_mov_b64 exec, 1
    buffer_store_dword v98, v87, s[4:7], s72 offen
    s_mov_b64 exec, -1
    v_mfma_f32_16x16x32_bf16 v[220:223], a[128:131], v[40:43], 0
    s_add_u32 m0, m0, 1024
    ds_read_b128 v[36:39], v5 offset:41984
    v_mfma_f32_16x16x32_bf16 v[220:223], a[132:135], v[44:47], v[220:223]
    s_add_u32 s73, s73, 4096
    ds_read_b128 v[40:43], v5 offset:43008
    v_mfma_f32_16x16x32_bf16 v[220:223], a[136:139], v[24:27], v[220:223]
    s_lshl_b32 s64, s66, 13
    ds_read_b128 v[44:47], v5 offset:44032
    v_mfma_f32_16x16x32_bf16 v[220:223], a[140:143], v[28:31], v[220:223]
    s_add_u32 s64, s64, 262144
    ds_read_b128 v[24:27], v5 offset:36864
    v_mfma_f32_16x16x32_bf16 v[220:223], a[160:163], v[32:35], v[220:223]
    s_waitcnt lgkmcnt(3)
    ds_read_b128 v[28:31], v5 offset:37888
    v_mfma_f32_16x16x32_bf16 v[220:223], a[164:167], v[36:39], v[220:223]
    s_waitcnt lgkmcnt(3)
    ds_read_b128 v[32:35], v5 offset:38912
    v_mfma_f32_16x16x32_bf16 v[220:223], a[168:171], v[40:43], v[220:223]
    s_waitcnt lgkmcnt(3)
    ds_read_b128 v[36:39], v5 offset:39936
    v_mfma_f32_16x16x32_bf16 v[220:223], a[172:175], v[44:47], v[220:223]
    s_waitcnt lgkmcnt(3)
    ds_read_b128 v[40:43], v5 offset:45056
    v_mfma_f32_16x16x32_bf16 v[220:223], a[144:147], v[24:27], v[220:223]
    s_waitcnt lgkmcnt(3)
    ds_read_b128 v[44:47], v5 offset:46080
    v_mfma_f32_16x16x32_bf16 v[220:223], a[148:151], v[28:31], v[220:223]
    s_waitcnt lgkmcnt(3)
    ds_read_b128 v[24:27], v5 offset:47104
    v_mfma_f32_16x16x32_bf16 v[220:223], a[152:155], v[32:35], v[220:223]
    s_waitcnt lgkmcnt(3)
    ds_read_b128 v[28:31], v5 offset:48128
    v_mfma_f32_16x16x32_bf16 v[220:223], a[156:159], v[36:39], v[220:223]
    s_waitcnt lgkmcnt(3)
    ds_read_b128 v[32:35], v5 offset:49152
    v_mfma_f32_16x16x32_bf16 v[220:223], a[176:179], v[40:43], v[220:223]
    s_waitcnt lgkmcnt(3)
    ds_read_b128 v[36:39], v5 offset:50176
    v_mfma_f32_16x16x32_bf16 v[220:223], a[180:183], v[44:47], v[220:223]
    s_waitcnt lgkmcnt(3)
    ds_read_b128 v[40:43], v5 offset:51200
    v_mfma_f32_16x16x32_bf16 v[220:223], a[184:187], v[24:27], v[220:223]
    s_waitcnt lgkmcnt(3)
    ds_read_b128 v[44:47], v5 offset:52224
    v_mfma_f32_16x16x32_bf16 v[220:223], a[188:191], v[28:31], v[220:223]
    s_waitcnt lgkmcnt(3)
    ds_read_b128 v[24:27], v5 offset:57344
    v_mfma_f32_16x16x32_bf16 v[224:227], a[128:131], v[32:35], 0
    s_waitcnt lgkmcnt(3)
    ds_read_b128 v[28:31], v5 offset:58368
    v_mfma_f32_16x16x32_bf16 v[224:227], a[132:135], v[36:39], v[224:227]
    s_waitcnt lgkmcnt(3)
    ds_read_b128 v[32:35], v5 offset:59392
    v_mfma_f32_16x16x32_bf16 v[224:227], a[136:139], v[40:43], v[224:227]
    s_waitcnt lgkmcnt(3)
    ds_read_b128 v[36:39], v5 offset:60416
    v_mfma_f32_16x16x32_bf16 v[224:227], a[140:143], v[44:47], v[224:227]
    s_waitcnt lgkmcnt(3)
    ds_read_b128 v[40:43], v5 offset:53248
    v_mfma_f32_16x16x32_bf16 v[224:227], a[160:163], v[24:27], v[224:227]
    s_waitcnt lgkmcnt(3)
    ds_read_b128 v[44:47], v5 offset:54272
    v_mfma_f32_16x16x32_bf16 v[224:227], a[164:167], v[28:31], v[224:227]
    s_waitcnt lgkmcnt(3)
    ds_read_b128 v[24:27], v5 offset:55296
    v_mfma_f32_16x16x32_bf16 v[224:227], a[168:171], v[32:35], v[224:227]
    s_waitcnt lgkmcnt(3)
    ds_read_b128 v[28:31], v5 offset:56320
    v_mfma_f32_16x16x32_bf16 v[224:227], a[172:175], v[36:39], v[224:227]
    s_waitcnt lgkmcnt(3)
    ds_read_b128 v[32:35], v5 offset:61440
    v_mfma_f32_16x16x32_bf16 v[224:227], a[144:147], v[40:43], v[224:227]
    s_waitcnt lgkmcnt(3)
    ds_read_b128 v[36:39], v5 offset:62464
    v_mfma_f32_16x16x32_bf16 v[224:227], a[148:151], v[44:47], v[224:227]
    s_waitcnt lgkmcnt(3)
    ds_read_b128 v[40:43], v5 offset:63488
    v_mfma_f32_16x16x32_bf16 v[224:227], a[152:155], v[24:27], v[224:227]
    s_waitcnt lgkmcnt(3)
    ds_read_b128 v[44:47], v5 offset:64512
    v_mfma_f32_16x16x32_bf16 v[224:227], a[156:159], v[28:31], v[224:227]
    s_waitcnt lgkmcnt(3)
    buffer_load_dwordx4 v86, s[32:35], s73 offen lds
    v_mfma_f32_16x16x32_bf16 v[224:227], a[176:179], v[32:35], v[224:227]
    s_waitcnt lgkmcnt(2)
    v_mfma_f32_16x16x32_bf16 v[224:227], a[180:183], v[36:39], v[224:227]
    s_waitcnt lgkmcnt(1)
    v_mfma_f32_16x16x32_bf16 v[224:227], a[184:187], v[40:43], v[224:227]
    s_waitcnt lgkmcnt(0)
    v_mfma_f32_16x16x32_bf16 v[224:227], a[188:191], v[44:47], v[224:227]
    s_add_u32 m0, m0, 1024
    v_mfma_f32_16x16x32_bf16 v[88:91], a[128:131], v[100:103], 0
    s_add_u32 s73, s73, 4096
    buffer_load_dwordx4 v86, s[32:35], s73 offen lds
    v_mfma_f32_16x16x32_bf16 v[88:91], a[132:135], v[100:103], v[88:91]
    s_add_u32 m0, m0, 1024
    v_mfma_f32_16x16x32_bf16 v[88:91], a[136:139], v[100:103], v[88:91]
    s_add_u32 s73, s73, 4096
    buffer_load_dwordx4 v86, s[32:35], s73 offen lds
    v_mfma_f32_16x16x32_bf16 v[88:91], a[140:143], v[100:103], v[88:91]
    s_add_u32 m0, m0, 1024
    v_mfma_f32_16x16x32_bf16 v[88:91], a[144:147], v[100:103], v[88:91]
    s_add_u32 s73, s73, 4096
    buffer_load_dwordx4 v86, s[32:35], s73 offen lds
    v_mfma_f32_16x16x32_bf16 v[88:91], a[148:151], v[100:103], v[88:91]
    s_add_u32 m0, m0, 1024
    v_mfma_f32_16x16x32_bf16 v[88:91], a[152:155], v[100:103], v[88:91]
    s_add_u32 s73, s73, 4096
    buffer_load_dwordx4 v86, s[32:35], s73 offen lds
    v_mfma_f32_16x16x32_bf16 v[88:91], a[156:159], v[100:103], v[88:91]
    s_add_u32 m0, m0, 1024
    v_mfma_f32_16x16x32_bf16 v[88:91], a[160:163], v[100:103], v[88:91]
    s_add_u32 s73, s73, 4096
    buffer_load_dwordx4 v86, s[32:35], s73 offen lds
    v_mfma_f32_16x16x32_bf16 v[88:91], a[164:167], v[100:103], v[88:91]
    s_add_u32 s65, s64, 4096
    v_mfma_f32_16x16x32_bf16 v[88:91], a[168:171], v[100:103], v[88:91]
    s_lshl_b32 s42, s66, 10
    v_mfma_f32_16x16x32_bf16 v[88:91], a[172:175], v[100:103], v[88:91]
    s_add_u32 s42, s42, 524288
    v_mfma_f32_16x16x32_bf16 v[88:91], a[176:179], v[100:103], v[88:91]
    s_and_b32 s58, s46, 1
    v_mfma_f32_16x16x32_bf16 v[88:91], a[180:183], v[100:103], v[88:91]
    s_lshl_b32 s71, s52, 8
    v_mfma_f32_16x16x32_bf16 v[88:91], a[184:187], v[100:103], v[88:91]
    s_add_u32 s69, s71, 16384
    v_mfma_f32_16x16x32_bf16 v[88:91], a[188:191], v[100:103], v[88:91]
    s_add_u32 s71, s71, 28672
    s_lshl_b32 s59, s53, 1
    s_add_u32 s58, s58, s59
    s_lshl_b32 s67, s58, 10
    s_lshl_b32 s58, s58, 2
    s_add_u32 s69, s69, s58
    s_lshr_b32 s58, s46, 1
    s_lshl_b32 s59, s58, 7
    s_add_u32 s69, s69, s59
    s_lshl_b32 s59, s52, 1
    s_add_u32 s58, s58, s59
    s_lshl_b32 s58, s58, 16
    s_add_u32 s67, s67, s58
    s_add_u32 s67, s67, 0
    s_add_u32 s68, s67, 0x8000
    s_waitcnt vmcnt(0)
    s_barrier
    s_add_u32 m0, s40, 32768
    s_add_u32 s73, s41, 262144
    v_pk_fma_f32 v[212:213], v[228:229], v[88:89], v[212:213] op_sel_hi:[0,1,1] neg_lo:[1,0,0] neg_hi:[1,0,0]
    v_pk_fma_f32 v[214:215], v[228:229], v[90:91], v[214:215] op_sel_hi:[0,1,1] neg_lo:[1,0,0] neg_hi:[1,0,0]
    v_pk_mul_f32 v[212:213], v[212:213], v[228:229] op_sel:[0,1] op_sel_hi:[1,1]
    v_pk_mul_f32 v[214:215], v[214:215], v[228:229] op_sel:[0,1] op_sel_hi:[1,1]
    v_exp_f32 v56, v212 clamp
    v_exp_f32 v57, v213 clamp
    buffer_load_dwordx4 v86, s[32:35], s73 offen lds
    s_add_u32 m0, m0, 1024
    s_add_u32 s73, s73, 4096
    v_exp_f32 v58, v214 clamp
    v_exp_f32 v59, v215 clamp
    v_pk_fma_f32 v[212:213], v[212:213], v[84:85], v[84:85] op_sel:[0,0,1] op_sel_hi:[1,0,1]
    v_pk_fma_f32 v[214:215], v[214:215], v[84:85], v[84:85] op_sel:[0,0,1] op_sel_hi:[1,0,1]
    v_pk_add_f32 v[56:57], v[56:57], s[92:93] op_sel_hi:[1,0]
    v_pk_add_f32 v[58:59], v[58:59], s[92:93] op_sel_hi:[1,0]
    buffer_load_dwordx4 v86, s[32:35], s73 offen lds
    s_add_u32 m0, m0, 1024
    s_add_u32 s73, s73, 4096
    v_max_f32 v212, v212, v56
    v_max_f32 v213, v213, v57
    v_max_f32 v214, v214, v58
    v_max_f32 v215, v215, v59
    v_cvt_pk_bf16_f32 v200, v212, v213
    v_cvt_pk_bf16_f32 v201, v214, v215
    buffer_load_dwordx4 v86, s[32:35], s73 offen lds
    s_add_u32 m0, m0, 1024
    s_add_u32 s73, s73, 4096
    v_pk_fma_f32 v[216:217], v[230:231], v[88:89], v[216:217] op_sel_hi:[0,1,1] neg_lo:[1,0,0] neg_hi:[1,0,0]
    v_pk_fma_f32 v[218:219], v[230:231], v[90:91], v[218:219] op_sel_hi:[0,1,1] neg_lo:[1,0,0] neg_hi:[1,0,0]
    v_pk_mul_f32 v[216:217], v[216:217], v[230:231] op_sel:[0,1] op_sel_hi:[1,1]
    v_pk_mul_f32 v[218:219], v[218:219], v[230:231] op_sel:[0,1] op_sel_hi:[1,1]
    v_exp_f32 v56, v216 clamp
    v_exp_f32 v57, v217 clamp
    buffer_load_dwordx4 v86, s[32:35], s73 offen lds
    s_add_u32 m0, m0, 1024
    s_add_u32 s73, s73, 4096
    v_exp_f32 v58, v218 clamp
    v_exp_f32 v59, v219 clamp
    v_pk_fma_f32 v[216:217], v[216:217], v[84:85], v[84:85] op_sel:[0,0,1] op_sel_hi:[1,0,1]
    v_pk_fma_f32 v[218:219], v[218:219], v[84:85], v[84:85] op_sel:[0,0,1] op_sel_hi:[1,0,1]
    v_pk_add_f32 v[56:57], v[56:57], s[92:93] op_sel_hi:[1,0]
    v_pk_add_f32 v[58:59], v[58:59], s[92:93] op_sel_hi:[1,0]
    buffer_load_dwordx4 v86, s[32:35], s73 offen lds
    s_add_u32 m0, m0, 1024
    s_add_u32 s73, s73, 4096
    v_max_f32 v216, v216, v56
    v_max_f32 v217, v217, v57
    v_max_f32 v218, v218, v58
    v_max_f32 v219, v219, v59
    v_cvt_pk_bf16_f32 v202, v216, v217
    v_cvt_pk_bf16_f32 v203, v218, v219
    buffer_load_dwordx4 v86, s[32:35], s73 offen lds
    s_add_u32 m0, m0, 1024
    s_add_u32 s73, s73, 4096
    v_pk_fma_f32 v[220:221], v[232:233], v[88:89], v[220:221] op_sel_hi:[0,1,1] neg_lo:[1,0,0] neg_hi:[1,0,0]
    v_pk_fma_f32 v[222:223], v[232:233], v[90:91], v[222:223] op_sel_hi:[0,1,1] neg_lo:[1,0,0] neg_hi:[1,0,0]
    v_pk_mul_f32 v[220:221], v[220:221], v[232:233] op_sel:[0,1] op_sel_hi:[1,1]
    v_pk_mul_f32 v[222:223], v[222:223], v[232:233] op_sel:[0,1] op_sel_hi:[1,1]
    v_exp_f32 v56, v220 clamp
    v_exp_f32 v57, v221 clamp
    buffer_load_dwordx4 v86, s[32:35], s73 offen lds
    s_add_u32 m0, m0, 1024
    s_add_u32 s73, s73, 4096
    v_exp_f32 v58, v222 clamp
    v_exp_f32 v59, v223 clamp
    v_pk_fma_f32 v[220:221], v[220:221], v[84:85], v[84:85] op_sel:[0,0,1] op_sel_hi:[1,0,1]
    v_pk_fma_f32 v[222:223], v[222:223], v[84:85], v[84:85] op_sel:[0,0,1] op_sel_hi:[1,0,1]
    v_pk_add_f32 v[56:57], v[56:57], s[92:93] op_sel_hi:[1,0]
    v_pk_add_f32 v[58:59], v[58:59], s[92:93] op_sel_hi:[1,0]
    buffer_load_dwordx4 v86, s[32:35], s73 offen lds
    v_max_f32 v220, v220, v56
    v_max_f32 v221, v221, v57
    v_max_f32 v222, v222, v58
    v_max_f32 v223, v223, v59
    v_cvt_pk_bf16_f32 v204, v220, v221
    v_cvt_pk_bf16_f32 v205, v222, v223
    v_pk_fma_f32 v[224:225], v[234:235], v[88:89], v[224:225] op_sel_hi:[0,1,1] neg_lo:[1,0,0] neg_hi:[1,0,0]
    v_pk_fma_f32 v[226:227], v[234:235], v[90:91], v[226:227] op_sel_hi:[0,1,1] neg_lo:[1,0,0] neg_hi:[1,0,0]
    v_pk_mul_f32 v[224:225], v[224:225], v[234:235] op_sel:[0,1] op_sel_hi:[1,1]
    v_pk_mul_f32 v[226:227], v[226:227], v[234:235] op_sel:[0,1] op_sel_hi:[1,1]
    v_exp_f32 v56, v224 clamp
    v_exp_f32 v57, v225 clamp
    buffer_load_dword v80, v210, s[4:7], s71 offen sc1
    buffer_load_dwordx4 v[40:43], v208, s[4:7], s42 offen sc1
    buffer_load_dwordx4 v[8:11], v1, s[4:7], s64 offen offset:0 sc1
    buffer_load_dwordx4 v[12:15], v1, s[4:7], s64 offen offset:1024 sc1
    buffer_load_dwordx4 v[16:19], v1, s[4:7], s64 offen offset:2048 sc1
    buffer_load_dwordx4 v[20:23], v1, s[4:7], s64 offen offset:3072 sc1
    buffer_load_dwordx4 v[24:27], v1, s[4:7], s65 offen offset:0 sc1
    buffer_load_dwordx4 v[28:31], v1, s[4:7], s65 offen offset:1024 sc1
    buffer_load_dwordx4 v[32:35], v1, s[4:7], s65 offen offset:2048 sc1
    buffer_load_dwordx4 v[36:39], v1, s[4:7], s65 offen offset:3072 sc1
    v_exp_f32 v58, v226 clamp
    v_exp_f32 v59, v227 clamp
    v_pk_fma_f32 v[224:225], v[224:225], v[84:85], v[84:85] op_sel:[0,0,1] op_sel_hi:[1,0,1]
    v_pk_fma_f32 v[226:227], v[226:227], v[84:85], v[84:85] op_sel:[0,0,1] op_sel_hi:[1,0,1]
    v_pk_add_f32 v[56:57], v[56:57], s[92:93] op_sel_hi:[1,0]
    v_pk_add_f32 v[58:59], v[58:59], s[92:93] op_sel_hi:[1,0]
    v_max_f32 v224, v224, v56
    v_max_f32 v225, v225, v57
    v_max_f32 v226, v226, v58
    v_max_f32 v227, v227, v59
    v_cvt_pk_bf16_f32 v206, v224, v225
    v_cvt_pk_bf16_f32 v207, v226, v227
    ds_read_b64_tr_b16 v[128:129], v195 offset:0
    ds_read_b64_tr_b16 v[130:131], v195 offset:4096
    ds_read_b64_tr_b16 a[192:193], v195 offset:8
    ds_read_b64_tr_b16 a[194:195], v195 offset:4104
    ds_read_b64_tr_b16 v[132:133], v195 offset:16384
    ds_read_b64_tr_b16 v[134:135], v195 offset:20480
    ds_read_b64_tr_b16 a[196:197], v195 offset:16392
    ds_read_b64_tr_b16 a[198:199], v195 offset:20488
    ds_read_b64_tr_b16 v[136:137], v196 offset:0
    ds_read_b64_tr_b16 v[138:139], v196 offset:4096
    ds_read_b64_tr_b16 a[200:201], v196 offset:8
    ds_read_b64_tr_b16 a[202:203], v196 offset:4104
    ds_read_b64_tr_b16 v[140:141], v196 offset:16384
    ds_read_b64_tr_b16 v[142:143], v196 offset:20480
    ds_read_b64_tr_b16 a[204:205], v196 offset:16392
    ds_read_b64_tr_b16 a[206:207], v196 offset:20488
    ds_read_b64_tr_b16 v[144:145], v195 offset:8192
    ds_read_b64_tr_b16 v[146:147], v195 offset:12288
    ds_read_b64_tr_b16 a[208:209], v195 offset:8200
    ds_read_b64_tr_b16 a[210:211], v195 offset:12296
    ds_read_b64_tr_b16 v[148:149], v195 offset:24576
    ds_read_b64_tr_b16 v[150:151], v195 offset:28672
    ds_read_b64_tr_b16 a[212:213], v195 offset:24584
    ds_read_b64_tr_b16 a[214:215], v195 offset:28680
    ds_read_b64_tr_b16 v[152:153], v196 offset:8192
    ds_read_b64_tr_b16 v[154:155], v196 offset:12288
    ds_read_b64_tr_b16 a[216:217], v196 offset:8200
    ds_read_b64_tr_b16 a[218:219], v196 offset:12296
    ds_read_b64_tr_b16 v[156:157], v196 offset:24576
    ds_read_b64_tr_b16 v[158:159], v196 offset:28672
    ds_read_b64_tr_b16 a[220:221], v196 offset:24584
    ds_read_b64_tr_b16 a[222:223], v196 offset:28680
L_kva37:
    s_waitcnt vmcnt(8)
    v_max3_u32 v52, v40, v41, v42
    v_max_u32 v52, v52, v43
    v_add_f32_dpp v44, v40, v40 row_ror:8 row_mask:0xf bank_mask:0xf
    v_add_f32_dpp v45, v41, v41 row_ror:8 row_mask:0xf bank_mask:0xf
    v_add_f32_dpp v46, v42, v42 row_ror:8 row_mask:0xf bank_mask:0xf
    v_add_f32_dpp v47, v43, v43 row_ror:8 row_mask:0xf bank_mask:0xf
    v_add_f32_dpp v44, v44, v44 row_ror:4 row_mask:0xf bank_mask:0xf
    v_add_f32_dpp v45, v45, v45 row_ror:4 row_mask:0xf bank_mask:0xf
    v_add_f32_dpp v46, v46, v46 row_ror:4 row_mask:0xf bank_mask:0xf
    v_add_f32_dpp v47, v47, v47 row_ror:4 row_mask:0xf bank_mask:0xf
    v_add_f32_dpp v44, v44, v44 row_ror:2 row_mask:0xf bank_mask:0xf
    v_add_f32_dpp v45, v45, v45 row_ror:2 row_mask:0xf bank_mask:0xf
    v_add_f32_dpp v46, v46, v46 row_ror:2 row_mask:0xf bank_mask:0xf
    v_add_f32_dpp v47, v47, v47 row_ror:2 row_mask:0xf bank_mask:0xf
    v_add_f32_dpp v44, v44, v44 row_ror:1 row_mask:0xf bank_mask:0xf
    v_add_f32_dpp v45, v45, v45 row_ror:1 row_mask:0xf bank_mask:0xf
    v_add_f32_dpp v46, v46, v46 row_ror:1 row_mask:0xf bank_mask:0xf
    v_add_f32_dpp v47, v47, v47 row_ror:1 row_mask:0xf bank_mask:0xf
    v_cvt_pk_bf16_f32 v62, v44, v45
    v_cvt_pk_bf16_f32 v63, v46, v47
    s_nop 1
    v_mfma_f32_16x16x16_bf16 v[236:239], v[62:63], v[200:201], 0
    v_mfma_f32_16x16x16_bf16 v[240:243], v[62:63], v[202:203], 0
    v_mfma_f32_16x16x16_bf16 v[244:247], v[62:63], v[204:205], 0
    v_mfma_f32_16x16x16_bf16 v[248:251], v[62:63], v[206:207], 0
    s_waitcnt vmcnt(7)
    v_max3_u32 v52, v52, v8, v9
    v_dot2_f32_bf16 v68, v8, s96, 0
    v_dot2_f32_bf16 v69, v8, s97, 0
    v_dot2_f32_bf16 v70, v9, s96, 0
    v_dot2_f32_bf16 v71, v9, s97, 0
    v_dot2_f32_bf16 v72, v10, s96, 0
    v_dot2_f32_bf16 v73, v10, s97, 0
    v_dot2_f32_bf16 v74, v11, s96, 0
    v_dot2_f32_bf16 v75, v11, s97, 0
    v_max3_u32 v52, v52, v10, v11
    s_waitcnt vmcnt(6)
    v_max3_u32 v52, v52, v12, v13
    v_dot2_f32_bf16 v68, v12, s96, v68
    v_dot2_f32_bf16 v69, v12, s97, v69
    v_dot2_f32_bf16 v70, v13, s96, v70
    v_dot2_f32_bf16 v71, v13, s97, v71
    v_dot2_f32_bf16 v72, v14, s96, v72
    v_dot2_f32_bf16 v73, v14, s97, v73
    v_dot2_f32_bf16 v74, v15, s96, v74
    v_dot2_f32_bf16 v75, v15, s97, v75
    v_max3_u32 v52, v52, v14, v15
    v_add_f32 v236, s92, v236
    v_add_f32 v240, s92, v240
    v_add_f32 v244, s92, v244
    v_add_f32 v248, s92, v248
    v_rcp_f32 v236, v236
    v_rcp_f32 v240, v240
    v_rcp_f32 v244, v244
    v_rcp_f32 v248, v248
    s_waitcnt vmcnt(5)
    v_max3_u32 v52, v52, v16, v17
    v_dot2_f32_bf16 v68, v16, s96, v68
    v_dot2_f32_bf16 v69, v16, s97, v69
    v_dot2_f32_bf16 v70, v17, s96, v70
    v_dot2_f32_bf16 v71, v17, s97, v71
    v_dot2_f32_bf16 v72, v18, s96, v72
    v_dot2_f32_bf16 v73, v18, s97, v73
    v_dot2_f32_bf16 v74, v19, s96, v74
    v_dot2_f32_bf16 v75, v19, s97, v75
    v_max3_u32 v52, v52, v18, v19
    s_waitcnt vmcnt(4)
    v_max3_u32 v52, v52, v20, v21
    v_dot2_f32_bf16 v68, v20, s96, v68
    v_dot2_f32_bf16 v69, v20, s97, v69
    v_dot2_f32_bf16 v70, v21, s96, v70
    v_dot2_f32_bf16 v71, v21, s97, v71
    v_dot2_f32_bf16 v72, v22, s96, v72
    v_dot2_f32_bf16 v73, v22, s97, v73
    v_dot2_f32_bf16 v74, v23, s96, v74
    v_dot2_f32_bf16 v75, v23, s97, v75
    v_max3_u32 v52, v52, v22, v23
    s_waitcnt vmcnt(3)
    v_max3_u32 v52, v52, v24, v25
    v_dot2_f32_bf16 v68, v24, s96, v68
    v_dot2_f32_bf16 v69, v24, s97, v69
    v_dot2_f32_bf16 v70, v25, s96, v70
    v_dot2_f32_bf16 v71, v25, s97, v71
    v_dot2_f32_bf16 v72, v26, s96, v72
    v_dot2_f32_bf16 v73, v26, s97, v73
    v_dot2_f32_bf16 v74, v27, s96, v74
    v_dot2_f32_bf16 v75, v27, s97, v75
    v_max3_u32 v52, v52, v26, v27
    s_waitcnt vmcnt(2)
    v_max3_u32 v52, v52, v28, v29
    v_dot2_f32_bf16 v68, v28, s96, v68
    v_dot2_f32_bf16 v69, v28, s97, v69
    v_dot2_f32_bf16 v70, v29, s96, v70
    v_dot2_f32_bf16 v71, v29, s97, v71
    v_dot2_f32_bf16 v72, v30, s96, v72
    v_dot2_f32_bf16 v73, v30, s97, v73
    v_dot2_f32_bf16 v74, v31, s96, v74
    v_dot2_f32_bf16 v75, v31, s97, v75
    v_max3_u32 v52, v52, v30, v31
    s_waitcnt vmcnt(1)
    v_max3_u32 v52, v52, v32, v33
    v_dot2_f32_bf16 v68, v32, s96, v68
    v_dot2_f32_bf16 v69, v32, s97, v69
    v_dot2_f32_bf16 v70, v33, s96, v70
    v_dot2_f32_bf16 v71, v33, s97, v71
    v_dot2_f32_bf16 v72, v34, s96, v72
    v_dot2_f32_bf16 v73, v34, s97, v73
    v_dot2_f32_bf16 v74, v35, s96, v74
    v_dot2_f32_bf16 v75, v35, s97, v75
    v_max3_u32 v52, v52, v34, v35
    s_waitcnt vmcnt(0)
    v_max3_u32 v52, v52, v36, v37
    v_dot2_f32_bf16 v68, v36, s96, v68
    v_dot2_f32_bf16 v69, v36, s97, v69
    v_dot2_f32_bf16 v70, v37, s96, v70
    v_dot2_f32_bf16 v71, v37, s97, v71
    v_dot2_f32_bf16 v72, v38, s96, v72
    v_dot2_f32_bf16 v73, v38, s97, v73
    v_dot2_f32_bf16 v74, v39, s96, v74
    v_dot2_f32_bf16 v75, v39, s97, v75
    v_max3_u32 v52, v52, v38, v39
    v_cmp_eq_u32 vcc, -1, v52
    s_cbranch_vccnz L_ool38
L_back39:
    v_cmp_ne_u32 vcc, s47, v80
    s_cbranch_vccnz L_ool40
L_back41:
    v_permlane32_swap_b32 v68, v72
    v_permlane32_swap_b32 v69, v73
    v_permlane32_swap_b32 v70, v74
    v_permlane32_swap_b32 v71, v75
    v_pk_add_f32 v[68:69], v[68:69], v[72:73]
    v_pk_add_f32 v[70:71], v[70:71], v[74:75]
    v_cvt_pk_bf16_f32 v60, v68, v69
    v_cvt_pk_bf16_f32 v61, v70, v71
    s_nop 1
    v_mfma_f32_16x16x16_bf16 v[8:11], v[60:61], v[200:201], 0
    v_mfma_f32_16x16x16_bf16 v[12:15], v[60:61], v[202:203], 0
    v_mfma_f32_16x16x16_bf16 v[16:19], v[60:61], v[204:205], 0
    v_mfma_f32_16x16x16_bf16 v[20:23], v[60:61], v[206:207], 0
    s_add_u32 m0, s40, 40960
    s_add_u32 s73, s41, 393216
    buffer_load_dwordx4 v86, s[32:35], s73 offen lds
    s_add_u32 m0, m0, 1024
    s_add_u32 s73, s73, 4096
    buffer_load_dwordx4 v86, s[32:35], s73 offen lds
    s_add_u32 m0, m0, 1024
    s_add_u32 s73, s73, 4096
    buffer_load_dwordx4 v86, s[32:35], s73 offen lds
    s_add_u32 m0, m0, 1024
    s_add_u32 s73, s73, 4096
    buffer_load_dwordx4 v86, s[32:35], s73 offen lds
    s_add_u32 m0, m0, 1024
    s_add_u32 s73, s73, 4096
    buffer_load_dwordx4 v86, s[32:35], s73 offen lds
    s_add_u32 m0, m0, 1024
    s_add_u32 s73, s73, 4096
    buffer_load_dwordx4 v86, s[32:35], s73 offen lds
    s_add_u32 m0, m0, 1024
    s_add_u32 s73, s73, 4096
    buffer_load_dwordx4 v86, s[32:35], s73 offen lds
    s_add_u32 m0, m0, 1024
    s_add_u32 s73, s73, 4096
    buffer_load_dwordx4 v86, s[32:35], s73 offen lds
    v_pk_mul_f32 v[8:9], v[8:9], v[236:237] op_sel_hi:[1,0]
    v_pk_mul_f32 v[10:11], v[10:11], v[236:237] op_sel_hi:[1,0]
    v_pk_mul_f32 v[12:13], v[12:13], v[240:241] op_sel_hi:[1,0]
    v_pk_mul_f32 v[14:15], v[14:15], v[240:241] op_sel_hi:[1,0]
    v_cvt_pk_bf16_f32 v40, v8, v9
    v_cvt_pk_bf16_f32 v41, v10, v11
    v_cvt_pk_bf16_f32 v42, v12, v13
    v_cvt_pk_bf16_f32 v43, v14, v15
    buffer_store_dwordx4 v[40:43], v1, s[36:39], s67 offen
    v_pk_mul_f32 v[16:17], v[16:17], v[244:245] op_sel_hi:[1,0]
    v_pk_mul_f32 v[18:19], v[18:19], v[244:245] op_sel_hi:[1,0]
    v_pk_mul_f32 v[20:21], v[20:21], v[248:249] op_sel_hi:[1,0]
    v_pk_mul_f32 v[22:23], v[22:23], v[248:249] op_sel_hi:[1,0]
    v_cvt_pk_bf16_f32 v44, v16, v17
    v_cvt_pk_bf16_f32 v45, v18, v19
    v_cvt_pk_bf16_f32 v46, v20, v21
    v_cvt_pk_bf16_f32 v47, v22, v23
    buffer_store_dwordx4 v[44:47], v1, s[36:39], s68 offen
    v_and_b32 v40, 7, v0
    v_lshlrev_b32 v40, 2, v40
    s_lshl_b32 s71, s50, 6
    s_and_b32 s71, s71, 0xffffff80
    s_lshl_b32 s58, s46, 5
    s_add_u32 s71, s71, s58
    s_add_u32 s71, s71, 16384
    s_lshl_b32 s64, s50, 15
    s_add_u32 s64, s64, 0
    v_add_u32 v41, s64, v1
    s_lshl_b32 s66, s46, 13
    s_add_u32 m0, s66, 131072
    v_add_u32 v197, 131072, v1
    s_lshl_b32 s72, s50, 6
    s_add_u32 s72, s72, 36864
    s_lshl_b32 s60, s51, 2
    s_add_u32 s68, s72, s60
    v_and_b32 v45, 3, v0
    v_lshlrev_b32 v45, 2, v45
    s_waitcnt vmcnt(0)
    s_cmp_lg_u32 s49, 0
    s_cbranch_scc1 L_ool42
L_back43:
    s_mov_b64 exec, 1
    buffer_store_dword v98, v2, s[4:7], s69 offen
    s_mov_b64 exec, -1
    s_barrier
    ds_read_b64_tr_b16 v[160:161], v195 offset:32768
    ds_read_b64_tr_b16 v[162:163], v195 offset:36864
    ds_read_b64_tr_b16 a[224:225], v195 offset:32776
    ds_read_b64_tr_b16 a[226:227], v195 offset:36872
    ds_read_b64_tr_b16 v[164:165], v195 offset:49152
    ds_read_b64_tr_b16 v[166:167], v195 offset:53248
    ds_read_b64_tr_b16 a[228:229], v195 offset:49160
    ds_read_b64_tr_b16 a[230:231], v195 offset:53256
    ds_read_b64_tr_b16 v[168:169], v196 offset:32768
    ds_read_b64_tr_b16 v[170:171], v196 offset:36864
    ds_read_b64_tr_b16 a[232:233], v196 offset:32776
    ds_read_b64_tr_b16 a[234:235], v196 offset:36872
    ds_read_b64_tr_b16 v[172:173], v196 offset:49152
    ds_read_b64_tr_b16 v[174:175], v196 offset:53248
    s_cmp_eq_u32 s49, 0
    s_cselect_b32 s57, 400000, 0
L_pl44:
    buffer_load_dword v42, v40, s[4:7], s71 offen sc1
    s_sub_u32 s57, s57, 1
    s_waitcnt vmcnt(0)
    v_cmp_ne_u32 vcc, s47, v42
    s_cbranch_scc1 L_ps46
    s_cbranch_vccnz L_pl44
L_pe47:
    buffer_load_dwordx4 v41, s[36:39], s66 offen offset:0 sc1 lds
    buffer_load_dwordx4 v41, s[36:39], s66 offen offset:1024 sc1 lds
    buffer_load_dwordx4 v41, s[36:39], s66 offen offset:2048 sc1 lds
    buffer_load_dwordx4 v41, s[36:39], s66 offen offset:3072 sc1 lds
    s_add_u32 m0, m0, 4096
    s_add_u32 s66, s66, 4096
    buffer_load_dwordx4 v41, s[36:39], s66 offen offset:0 sc1 lds
    buffer_load_dwordx4 v41, s[36:39], s66 offen offset:1024 sc1 lds
    buffer_load_dwordx4 v41, s[36:39], s66 offen offset:2048 sc1 lds
    buffer_load_dwordx4 v41, s[36:39], s66 offen offset:3072 sc1 lds
    ds_read_b64_tr_b16 a[236:237], v196 offset:49160
    ds_read_b64_tr_b16 a[238:239], v196 offset:53256
    ds_read_b64_tr_b16 v[176:177], v195 offset:40960
    ds_read_b64_tr_b16 v[178:179], v195 offset:45056
    ds_read_b64_tr_b16 a[240:241], v195 offset:40968
    ds_read_b64_tr_b16 a[242:243], v195 offset:45064
    ds_read_b64_tr_b16 v[180:181], v195 offset:57344
    ds_read_b64_tr_b16 v[182:183], v195 offset:61440
    ds_read_b64_tr_b16 a[244:245], v195 offset:57352
    ds_read_b64_tr_b16 a[246:247], v195 offset:61448
    ds_read_b64_tr_b16 v[184:185], v196 offset:40960
    ds_read_b64_tr_b16 v[186:187], v196 offset:45056
    ds_read_b64_tr_b16 a[248:249], v196 offset:40968
    ds_read_b64_tr_b16 a[250:251], v196 offset:45064
    ds_read_b64_tr_b16 v[188:189], v196 offset:57344
    ds_read_b64_tr_b16 v[190:191], v196 offset:61440
    ds_read_b64_tr_b16 a[252:253], v196 offset:57352
    ds_read_b64_tr_b16 a[254:255], v196 offset:61448
    s_waitcnt vmcnt(6)
    s_barrier
    ds_read_b128 v[8:11], v197 offset:0
    ds_read_b128 v[12:15], v197 offset:1024
    ds_read_b128 v[16:19], v197 offset:8192
    ds_read_b128 v[20:23], v197 offset:9216
    ds_read_b128 v[24:27], v197 offset:16384
    ds_read_b128 v[28:31], v197 offset:17408
    s_waitcnt lgkmcnt(4)
    v_swap_b32 v10, v12
    v_swap_b32 v11, v13
    s_nop 1
    v_mfma_f32_16x16x32_bf16 v[112:115], v[128:131], v[8:11], v[112:115]
    s_waitcnt lgkmcnt(2)
    v_swap_b32 v18, v20
    v_mfma_f32_16x16x32_bf16 v[116:119], a[192:195], v[8:11], v[116:119]
    v_swap_b32 v19, v21
    v_mfma_f32_16x16x32_bf16 v[120:123], v[128:131], v[12:15], v[120:123]
    ds_read_b128 v[32:35], v197 offset:24576
    v_mfma_f32_16x16x32_bf16 v[124:127], a[192:195], v[12:15], v[124:127]
    ds_read_b128 v[36:39], v197 offset:25600
    v_mfma_f32_16x16x32_bf16 v[112:115], v[144:147], v[16:19], v[112:115]
    s_waitcnt lgkmcnt(2)
    v_swap_b32 v26, v28
    v_mfma_f32_16x16x32_bf16 v[116:119], a[208:211], v[16:19], v[116:119]
    v_swap_b32 v27, v29
    v_mfma_f32_16x16x32_bf16 v[120:123], v[144:147], v[20:23], v[120:123]
    s_waitcnt vmcnt(0)
    s_barrier
    ds_read_b128 v[8:11], v197 offset:2048
    v_mfma_f32_16x16x32_bf16 v[124:127], a[208:211], v[20:23], v[124:127]
    ds_read_b128 v[12:15], v197 offset:3072
    v_mfma_f32_16x16x32_bf16 v[112:115], v[160:163], v[24:27], v[112:115]
    s_waitcnt lgkmcnt(2)
    v_swap_b32 v34, v36
    v_mfma_f32_16x16x32_bf16 v[116:119], a[224:227], v[24:27], v[116:119]
    v_swap_b32 v35, v37
    v_mfma_f32_16x16x32_bf16 v[120:123], v[160:163], v[28:31], v[120:123]
    ds_read_b128 v[16:19], v197 offset:10240
    v_mfma_f32_16x16x32_bf16 v[124:127], a[224:227], v[28:31], v[124:127]
    ds_read_b128 v[20:23], v197 offset:11264
    v_mfma_f32_16x16x32_bf16 v[112:115], v[176:179], v[32:35], v[112:115]
    s_waitcnt lgkmcnt(2)
    v_swap_b32 v10, v12
    v_mfma_f32_16x16x32_bf16 v[116:119], a[240:243], v[32:35], v[116:119]
    v_swap_b32 v11, v13
    v_mfma_f32_16x16x32_bf16 v[120:123], v[176:179], v[36:39], v[120:123]
    ds_read_b128 v[24:27], v197 offset:18432
    v_mfma_f32_16x16x32_bf16 v[124:127], a[240:243], v[36:39], v[124:127]
    ds_read_b128 v[28:31], v197 offset:19456
    v_mfma_f32_16x16x32_bf16 v[112:115], v[132:135], v[8:11], v[112:115]
    s_waitcnt lgkmcnt(2)
    v_swap_b32 v18, v20
    v_mfma_f32_16x16x32_bf16 v[116:119], a[196:199], v[8:11], v[116:119]
    v_swap_b32 v19, v21
    v_mfma_f32_16x16x32_bf16 v[120:123], v[132:135], v[12:15], v[120:123]
    ds_read_b128 v[32:35], v197 offset:26624
    v_mfma_f32_16x16x32_bf16 v[124:127], a[196:199], v[12:15], v[124:127]
    ds_read_b128 v[36:39], v197 offset:27648
    v_mfma_f32_16x16x32_bf16 v[112:115], v[148:151], v[16:19], v[112:115]
    s_waitcnt lgkmcnt(2)
    v_swap_b32 v26, v28
    v_mfma_f32_16x16x32_bf16 v[116:119], a[212:215], v[16:19], v[116:119]
    v_swap_b32 v27, v29
    v_mfma_f32_16x16x32_bf16 v[120:123], v[148:151], v[20:23], v[120:123]
    ds_read_b128 v[8:11], v197 offset:4096
    v_mfma_f32_16x16x32_bf16 v[124:127], a[212:215], v[20:23], v[124:127]
    ds_read_b128 v[12:15], v197 offset:5120
    v_mfma_f32_16x16x32_bf16 v[112:115], v[164:167], v[24:27], v[112:115]
    s_waitcnt lgkmcnt(2)
    v_swap_b32 v34, v36
    v_mfma_f32_16x16x32_bf16 v[116:119], a[228:231], v[24:27], v[116:119]
    v_swap_b32 v35, v37
    v_mfma_f32_16x16x32_bf16 v[120:123], v[164:167], v[28:31], v[120:123]
    ds_read_b128 v[16:19], v197 offset:12288
    v_mfma_f32_16x16x32_bf16 v[124:127], a[228:231], v[28:31], v[124:127]
    ds_read_b128 v[20:23], v197 offset:13312
    v_mfma_f32_16x16x32_bf16 v[112:115], v[180:183], v[32:35], v[112:115]
    s_waitcnt lgkmcnt(2)
    v_swap_b32 v10, v12
    v_mfma_f32_16x16x32_bf16 v[116:119], a[244:247], v[32:35], v[116:119]
    v_swap_b32 v11, v13
    v_mfma_f32_16x16x32_bf16 v[120:123], v[180:183], v[36:39], v[120:123]
    ds_read_b128 v[24:27], v197 offset:20480
    v_mfma_f32_16x16x32_bf16 v[124:127], a[244:247], v[36:39], v[124:127]
    ds_read_b128 v[28:31], v197 offset:21504
    v_mfma_f32_16x16x32_bf16 v[112:115], v[136:139], v[8:11], v[112:115]
    s_waitcnt lgkmcnt(2)
    v_swap_b32 v18, v20
    v_mfma_f32_16x16x32_bf16 v[116:119], a[200:203], v[8:11], v[116:119]
    v_swap_b32 v19, v21
    v_mfma_f32_16x16x32_bf16 v[120:123], v[136:139], v[12:15], v[120:123]
    ds_read_b128 v[32:35], v197 offset:28672
    v_mfma_f32_16x16x32_bf16 v[124:127], a[200:203], v[12:15], v[124:127]
    ds_read_b128 v[36:39], v197 offset:29696
    v_mfma_f32_16x16x32_bf16 v[112:115], v[152:155], v[16:19], v[112:115]
    s_waitcnt lgkmcnt(2)
    v_swap_b32 v26, v28
    v_mfma_f32_16x16x32_bf16 v[116:119], a[216:219], v[16:19], v[116:119]
    v_swap_b32 v27, v29
    v_mfma_f32_16x16x32_bf16 v[120:123], v[152:155], v[20:23], v[120:123]
    ds_read_b128 v[8:11], v197 offset:6144
    v_mfma_f32_16x16x32_bf16 v[124:127], a[216:219], v[20:23], v[124:127]
    ds_read_b128 v[12:15], v197 offset:7168
    v_mfma_f32_16x16x32_bf16 v[112:115], v[168:171], v[24:27], v[112:115]
    s_waitcnt lgkmcnt(2)
    v_swap_b32 v34, v36
    v_mfma_f32_16x16x32_bf16 v[116:119], a[232:235], v[24:27], v[116:119]
    v_swap_b32 v35, v37
    v_mfma_f32_16x16x32_bf16 v[120:123], v[168:171], v[28:31], v[120:123]
    ds_read_b128 v[16:19], v197 offset:14336
    v_mfma_f32_16x16x32_bf16 v[124:127], a[232:235], v[28:31], v[124:127]
    ds_read_b128 v[20:23], v197 offset:15360
    v_mfma_f32_16x16x32_bf16 v[112:115], v[184:187], v[32:35], v[112:115]
    s_waitcnt lgkmcnt(2)
    v_swap_b32 v10, v12
    v_mfma_f32_16x16x32_bf16 v[116:119], a[248:251], v[32:35], v[116:119]
    v_swap_b32 v11, v13
    v_mfma_f32_16x16x32_bf16 v[120:123], v[184:187], v[36:39], v[120:123]
    ds_read_b128 v[24:27], v197 offset:22528
    v_mfma_f32_16x16x32_bf16 v[124:127], a[248:251], v[36:39], v[124:127]
    ds_read_b128 v[28:31], v197 offset:23552
    v_mfma_f32_16x16x32_bf16 v[112:115], v[140:143], v[8:11], v[112:115]
    s_waitcnt lgkmcnt(2)
    v_swap_b32 v18, v20
    v_mfma_f32_16x16x32_bf16 v[116:119], a[204:207], v[8:11], v[116:119]
    v_swap_b32 v19, v21
    v_mfma_f32_16x16x32_bf16 v[120:123], v[140:143], v[12:15], v[120:123]
    ds_read_b128 v[32:35], v197 offset:30720
    v_mfma_f32_16x16x32_bf16 v[124:127], a[204:207], v[12:15], v[124:127]
    ds_read_b128 v[36:39], v197 offset:31744
    v_mfma_f32_16x16x32_bf16 v[112:115], v[156:159], v[16:19], v[112:115]
    s_waitcnt lgkmcnt(2)
    v_swap_b32 v26, v28
    v_mfma_f32_16x16x32_bf16 v[116:119], a[220:223], v[16:19], v[116:119]
    v_swap_b32 v27, v29
    v_mfma_f32_16x16x32_bf16 v[120:123], v[156:159], v[20:23], v[120:123]
    v_mfma_f32_16x16x32_bf16 v[124:127], a[220:223], v[20:23], v[124:127]
    v_mfma_f32_16x16x32_bf16 v[112:115], v[172:175], v[24:27], v[112:115]
    s_waitcnt lgkmcnt(0)
    v_swap_b32 v34, v36
    v_mfma_f32_16x16x32_bf16 v[116:119], a[236:239], v[24:27], v[116:119]
    v_swap_b32 v35, v37
    v_mfma_f32_16x16x32_bf16 v[120:123], v[172:175], v[28:31], v[120:123]
    v_mfma_f32_16x16x32_bf16 v[124:127], a[236:239], v[28:31], v[124:127]
    v_mfma_f32_16x16x32_bf16 v[112:115], v[188:191], v[32:35], v[112:115]
    v_mfma_f32_16x16x32_bf16 v[116:119], a[252:255], v[32:35], v[116:119]
    v_mfma_f32_16x16x32_bf16 v[120:123], v[188:191], v[36:39], v[120:123]
    v_mfma_f32_16x16x32_bf16 v[124:127], a[252:255], v[36:39], v[124:127]
    s_nop 4
    v_pk_add_f32 v[16:17], v[112:113], v[114:115]
    v_pk_mul_f32 v[18:19], v[112:113], v[112:113]
    v_pk_add_f32 v[16:17], v[16:17], v[116:117]
    v_pk_fma_f32 v[18:19], v[114:115], v[114:115], v[18:19]
    v_pk_add_f32 v[16:17], v[16:17], v[118:119]
    v_pk_fma_f32 v[18:19], v[116:117], v[116:117], v[18:19]
    v_pk_fma_f32 v[18:19], v[118:119], v[118:119], v[18:19]
    v_pk_add_f32 v[20:21], v[120:121], v[122:123]
    v_pk_mul_f32 v[22:23], v[120:121], v[120:121]
    v_pk_add_f32 v[20:21], v[20:21], v[124:125]
    v_pk_fma_f32 v[22:23], v[122:123], v[122:123], v[22:23]
    v_pk_add_f32 v[20:21], v[20:21], v[126:127]
    v_pk_fma_f32 v[22:23], v[124:125], v[124:125], v[22:23]
    v_pk_fma_f32 v[22:23], v[126:127], v[126:127], v[22:23]
    v_add_f32 v16, v16, v17
    v_add_f32 v18, v18, v19
    v_add_f32 v20, v20, v21
    v_add_f32 v22, v22, v23
    s_lshl_b32 s58, s46, 2
    s_add_u32 s58, s58, 0
    v_permlane32_swap_b32 v16, v18
    v_permlane32_swap_b32 v20, v22
    v_add_f32 v16, v16, v18
    v_add_f32 v20, v20, v22
    v_add_u32 v17, s58, v1
    s_nop 0
    v_permlane16_swap_b32 v16, v20
    v_add_f32 v16, v16, v20
    ds_write_b32 v17, v16
    s_waitcnt lgkmcnt(0)
    s_barrier
    ds_read_b128 v[16:19], v1 offset:0
    s_add_u32 s58, s3, 0
    s_add_u32 s70, s48, 894229078
    s_waitcnt lgkmcnt(0)
    v_pk_add_f32 v[16:17], v[16:17], v[18:19]
    v_add_f32 v16, v16, v17
    v_xor_b32 v17, s70, v16
    buffer_store_dwordx2 v[16:17], v83, s[4:7], s58 offen
    s_cmp_lg_u32 s49, 0
    s_cbranch_scc1 L_ool49
L_back50:
    s_lshl_b32 s58, s51, 2
    s_add_u32 s60, s58, s46
    s_lshl_b32 s58, s60, 10
    s_lshl_b32 s59, s50, 15
    s_add_u32 s58, s58, s59
    s_add_u32 s64, s58, 0
    s_add_u32 s65, s64, 0x4000
    s_lshl_b32 s68, s50, 4
    s_add_u32 s68, s68, s60
    s_lshl_b32 s68, s68, 2
    s_add_u32 s68, s68, 12288
    v_lshlrev_b32 v24, 16, v104
    v_and_b32 v25, s90, v104
    v_lshlrev_b32 v26, 16, v105
    v_and_b32 v27, s90, v105
    v_lshlrev_b32 v28, 16, v106
    v_and_b32 v29, s90, v106
    v_lshlrev_b32 v30, 16, v107
    v_and_b32 v31, s90, v107
    v_lshlrev_b32 v32, 16, v108
    v_and_b32 v33, s90, v108
    v_lshlrev_b32 v34, 16, v109
    v_and_b32 v35, s90, v109
    v_lshlrev_b32 v36, 16, v110
    v_and_b32 v37, s90, v110
    v_lshlrev_b32 v38, 16, v111
    v_and_b32 v39, s90, v111
    s_lshl_b32 s69, s50, 11
    s_add_u32 s69, s69, 1048576
    buffer_load_dwordx4 v[8:11], v1, s[4:7], s69 offen offset:0 sc1
    buffer_load_dwordx4 v[12:15], v1, s[4:7], s69 offen offset:1024 sc1
    s_add_u32 s70, s48, 894229078
    s_waitcnt vmcnt(1)
    v_bitop3_b32 v16, v8, v9, s70 bitop3:0x96
    v_bitop3_b32 v17, v10, v11, s70 bitop3:0x96
    s_waitcnt vmcnt(0)
    v_bitop3_b32 v18, v12, v13, s70 bitop3:0x96
    v_bitop3_b32 v19, v14, v15, s70 bitop3:0x96
    v_or3_b32 v16, v16, v17, v18
    v_or_b32 v16, v16, v19
    v_cmp_ne_u32 vcc, 0, v16
    s_cbranch_vccnz L_ool51
L_back52:
    v_add_f32 v8, v8, v12
    v_add_f32 v10, v10, v14
    s_nop 1
    v_permlane32_swap_b32 v8, v10
    v_add_f32 v8, v8, v10
    v_mul_f32 v8, s93, v8
    v_mov_b32 v9, v8
    s_nop 1
    v_permlane32_swap_b32 v8, v9
    v_fma_f32 v9, -v8, v8, v9
    v_cvt_pk_bf16_f32 v8, v8, v8
    v_max_f32 v9, 0, v9
    v_add_f32 v9, s94, v9
    v_rsq_f32 v9, v9
    v_and_b32 v8, s90, v8
    v_mul_f32 v10, -v8, v9
    v_mov_b32 v12, v9
    v_mov_b32 v8, v9
    v_mov_b32 v13, v10
    v_mov_b32 v9, v10
    v_permlane16_swap_b32 v8, v12
    s_nop 0
    v_permlane16_swap_b32 v9, v13
    v_pk_fma_f32 v[56:57], v[112:113], v[8:9], v[8:9] op_sel:[0,0,1] op_sel_hi:[1,0,1]
    v_pk_fma_f32 v[58:59], v[114:115], v[8:9], v[8:9] op_sel:[0,0,1] op_sel_hi:[1,0,1]
    v_pk_fma_f32 v[60:61], v[116:117], v[8:9], v[8:9] op_sel:[0,0,1] op_sel_hi:[1,0,1]
    v_pk_fma_f32 v[62:63], v[118:119], v[8:9], v[8:9] op_sel:[0,0,1] op_sel_hi:[1,0,1]
    v_pk_fma_f32 v[64:65], v[120:121], v[12:13], v[12:13] op_sel:[0,0,1] op_sel_hi:[1,0,1]
    v_pk_fma_f32 v[66:67], v[122:123], v[12:13], v[12:13] op_sel:[0,0,1] op_sel_hi:[1,0,1]
    v_pk_fma_f32 v[68:69], v[124:125], v[12:13], v[12:13] op_sel:[0,0,1] op_sel_hi:[1,0,1]
    v_pk_fma_f32 v[70:71], v[126:127], v[12:13], v[12:13] op_sel:[0,0,1] op_sel_hi:[1,0,1]
    v_pk_fma_f32 v[112:113], v[56:57], v[24:25], v[112:113]
    v_pk_fma_f32 v[114:115], v[58:59], v[26:27], v[114:115]
    v_pk_fma_f32 v[116:117], v[60:61], v[28:29], v[116:117]
    v_pk_fma_f32 v[118:119], v[62:63], v[30:31], v[118:119]
    v_cvt_pk_bf16_f32 v40, v112, v113
    v_cvt_pk_bf16_f32 v41, v114, v115
    v_cvt_pk_bf16_f32 v42, v116, v117
    v_cvt_pk_bf16_f32 v43, v118, v119
    buffer_store_dwordx4 v[40:43], v1, s[36:39], s64 offen
    v_pk_fma_f32 v[120:121], v[64:65], v[32:33], v[120:121]
    v_pk_fma_f32 v[122:123], v[66:67], v[34:35], v[122:123]
    v_pk_fma_f32 v[124:125], v[68:69], v[36:37], v[124:125]
    v_pk_fma_f32 v[126:127], v[70:71], v[38:39], v[126:127]
    v_cvt_pk_bf16_f32 v44, v120, v121
    v_cvt_pk_bf16_f32 v45, v122, v123
    v_cvt_pk_bf16_f32 v46, v124, v125
    v_cvt_pk_bf16_f32 v47, v126, v127
    buffer_store_dwordx4 v[44:47], v1, s[36:39], s65 offen
    v_pk_add_f32 v[16:17], v[112:113], v[114:115]
    v_pk_mul_f32 v[18:19], v[112:113], v[112:113]
    v_pk_add_f32 v[16:17], v[16:17], v[116:117]
    v_pk_fma_f32 v[18:19], v[114:115], v[114:115], v[18:19]
    v_pk_add_f32 v[16:17], v[16:17], v[118:119]
    v_pk_fma_f32 v[18:19], v[116:117], v[116:117], v[18:19]
    v_pk_fma_f32 v[18:19], v[118:119], v[118:119], v[18:19]
    v_pk_add_f32 v[20:21], v[120:121], v[122:123]
    v_pk_mul_f32 v[22:23], v[120:121], v[120:121]
    v_pk_add_f32 v[20:21], v[20:21], v[124:125]
    v_pk_fma_f32 v[22:23], v[122:123], v[122:123], v[22:23]
    v_pk_add_f32 v[20:21], v[20:21], v[126:127]
    v_pk_fma_f32 v[22:23], v[124:125], v[124:125], v[22:23]
    v_pk_fma_f32 v[22:23], v[126:127], v[126:127], v[22:23]
    v_add_f32 v16, v16, v17
    v_add_f32 v18, v18, v19
    v_add_f32 v20, v20, v21
    v_add_f32 v22, v22, v23
    s_lshl_b32 s58, s46, 2
    s_add_u32 s58, s58, 1024
    v_permlane32_swap_b32 v16, v18
    v_permlane32_swap_b32 v20, v22
    v_add_f32 v16, v16, v18
    v_add_f32 v20, v20, v22
    v_add_u32 v17, s58, v1
    s_nop 0
    v_permlane16_swap_b32 v16, v20
    v_add_f32 v16, v16, v20
    ds_write_b32 v17, v16
    s_waitcnt lgkmcnt(0)
    s_barrier
    ds_read_b128 v[16:19], v1 offset:1024
    s_add_u32 s58, s3, 131072
    s_add_u32 s70, s48, 1908133320
    s_waitcnt lgkmcnt(0)
    v_pk_add_f32 v[16:17], v[16:17], v[18:19]
    v_add_f32 v16, v16, v17
    v_xor_b32 v17, s70, v16
    buffer_store_dwordx2 v[16:17], v83, s[4:7], s58 offen
    s_cmp_lg_u32 s49, 0
    s_cbranch_scc1 L_ool53
L_back54:
    s_lshl_b32 s71, s52, 8
    s_add_u32 s72, s71, 32768
    s_add_u32 s71, s71, 12288
    s_lshl_b32 s58, s53, 2
    s_add_u32 s72, s72, s58
    s_lshl_b32 s78, s52, 2
    s_add_u32 s78, s78, s46
    s_lshl_b32 s78, s78, 11
    s_add_u32 s78, s78, 1179648
    s_lshr_b32 s58, s46, 1
    s_lshl_b32 s79, s58, 16
    s_and_b32 s58, s46, 1
    s_lshl_b32 s58, s58, 13
    s_add_u32 s66, s79, s58
    v_lshlrev_b32 v40, 2, v0
    s_waitcnt vmcnt(1)
    s_cmp_lg_u32 s49, 0
    s_cbranch_scc1 L_ool55
L_back56:
    s_mov_b64 exec, 1
    buffer_store_dword v98, v2, s[4:7], s68 offen
    s_mov_b64 exec, -1
    s_cmp_eq_u32 s49, 0
    s_cselect_b32 s57, 400000, 0
L_pl57:
    buffer_load_dword v42, v40, s[4:7], s71 offen sc1
    s_sub_u32 s57, s57, 1
    s_waitcnt vmcnt(0)
    v_cmp_ne_u32 vcc, s47, v42
    s_cbranch_scc1 L_ps59
    s_cbranch_vccnz L_pl57
L_pe60:
    s_mov_b32 m0, s66
    s_nop 0
    buffer_load_dwordx4 v192, s[36:39], m0 offen offset:0 sc1 lds
    buffer_load_dwordx4 v192, s[36:39], m0 offen offset:1024 sc1 lds
    buffer_load_dwordx4 v192, s[36:39], m0 offen offset:2048 sc1 lds
    buffer_load_dwordx4 v192, s[36:39], m0 offen offset:3072 sc1 lds
    buffer_load_dwordx4 v[48:51], v1, s[4:7], s78 offen offset:0 sc1
    buffer_load_dwordx4 v[52:55], v1, s[4:7], s78 offen offset:1024 sc1
    s_add_u32 m0, m0, 4096
    s_nop 0
    buffer_load_dwordx4 v192, s[36:39], m0 offen offset:0 sc1 lds
    buffer_load_dwordx4 v192, s[36:39], m0 offen offset:1024 sc1 lds
    buffer_load_dwordx4 v192, s[36:39], m0 offen offset:2048 sc1 lds
    buffer_load_dwordx4 v192, s[36:39], m0 offen offset:3072 sc1 lds
    s_add_u32 m0, m0, 12288
    s_nop 0
    buffer_load_dwordx4 v192, s[36:39], m0 offen offset:0 sc1 lds
    buffer_load_dwordx4 v192, s[36:39], m0 offen offset:1024 sc1 lds
    s_waitcnt vmcnt(8)
    s_barrier
    ds_read_b128 v[24:27], v5 offset:0
    ds_read_b128 v[28:31], v5 offset:1024
    ds_read_b128 v[32:35], v5 offset:2048
    ds_read_b128 v[36:39], v5 offset:3072
    ds_read_b128 v[40:43], v5 offset:8192
    s_waitcnt lgkmcnt(4)
    v_mfma_f32_16x16x32_bf16 v[8:11], v[24:27], a[0:3], 0
    buffer_load_dwordx4 v192, s[36:39], m0 offen offset:2048 sc1 lds
    v_mfma_f32_16x16x32_bf16 v[12:15], v[24:27], a[64:67], 0
    s_waitcnt vmcnt(8)
    v_bitop3_b32 v56, v48, v49, s70 bitop3:0x96
    v_mfma_f32_16x16x32_bf16 v[212:215], a[128:131], v[24:27], 0
    ds_read_b128 v[44:47], v5 offset:9216
    v_bitop3_b32 v57, v50, v51, s70 bitop3:0x96
    s_waitcnt lgkmcnt(4)
    v_mfma_f32_16x16x32_bf16 v[8:11], v[28:31], a[4:7], v[8:11]
    buffer_load_dwordx4 v192, s[36:39], m0 offen offset:3072 sc1 lds
    s_waitcnt vmcnt(8)
    v_bitop3_b32 v58, v52, v53, s70 bitop3:0x96
    v_mfma_f32_16x16x32_bf16 v[12:15], v[28:31], a[68:71], v[12:15]
    s_waitcnt lgkmcnt(2)
    v_bitop3_b32 v59, v54, v55, s70 bitop3:0x96
    v_or3_b32 v56, v56, v57, v58
    v_mfma_f32_16x16x32_bf16 v[212:215], a[132:135], v[28:31], v[212:215]
    s_add_u32 m0, m0, 4096
    ds_read_b128 v[24:27], v5 offset:10240
    v_or_b32 v56, v56, v59
    v_mfma_f32_16x16x32_bf16 v[8:11], v[32:35], a[8:11], v[8:11]
    v_cmp_ne_u32 vcc, 0, v56
    v_mfma_f32_16x16x32_bf16 v[12:15], v[32:35], a[72:75], v[12:15]
    s_cbranch_vccnz L_ool62
L_back63:
    v_add_f32 v48, v48, v52
    v_add_f32 v50, v50, v54
    v_mfma_f32_16x16x32_bf16 v[212:215], a[136:139], v[32:35], v[212:215]
    ds_read_b128 v[28:31], v5 offset:11264
    v_mfma_f32_16x16x32_bf16 v[8:11], v[36:39], a[12:15], v[8:11]
    buffer_load_dwordx4 v192, s[36:39], m0 offen offset:0 sc1 lds
    v_mfma_f32_16x16x32_bf16 v[12:15], v[36:39], a[76:79], v[12:15]
    s_waitcnt lgkmcnt(2)
    v_permlane32_swap_b32 v48, v50
    v_mfma_f32_16x16x32_bf16 v[212:215], a[140:143], v[36:39], v[212:215]
    v_add_f32 v48, v48, v50
    v_mul_f32 v48, s93, v48
    v_mfma_f32_16x16x32_bf16 v[8:11], v[40:43], a[32:35], v[8:11]
    buffer_load_dwordx4 v192, s[36:39], m0 offen offset:1024 sc1 lds
    v_mov_b32 v49, v48
    v_mfma_f32_16x16x32_bf16 v[12:15], v[40:43], a[96:99], v[12:15]
    s_nop 0
    v_permlane32_swap_b32 v48, v49
    v_mfma_f32_16x16x32_bf16 v[212:215], a[160:163], v[40:43], v[212:215]
    v_fma_f32 v49, -v48, v48, v49
    v_cvt_pk_bf16_f32 v48, v48, v48
    v_mfma_f32_16x16x32_bf16 v[8:11], v[44:47], a[36:39], v[8:11]
    v_max_f32 v49, 0, v49
    v_add_f32 v49, s94, v49
    v_mfma_f32_16x16x32_bf16 v[12:15], v[44:47], a[100:103], v[12:15]
    s_waitcnt lgkmcnt(0)
    v_rsq_f32 v49, v49
    v_mfma_f32_16x16x32_bf16 v[212:215], a[164:167], v[44:47], v[212:215]
    s_waitcnt vmcnt(6)
    s_barrier
    ds_read_b128 v[32:35], v5 offset:4096
    v_and_b32 v48, s90, v48
    v_mfma_f32_16x16x32_bf16 v[8:11], v[24:27], a[40:43], v[8:11]
    buffer_load_dwordx4 v192, s[36:39], m0 offen offset:2048 sc1 lds
    v_mul_f32 v49, s95, v49
    v_mfma_f32_16x16x32_bf16 v[12:15], v[24:27], a[104:107], v[12:15]
    ds_read_b128 v[36:39], v5 offset:5120
    v_cmp_gt_u32 vcc, 32, v0
    v_mfma_f32_16x16x32_bf16 v[212:215], a[168:171], v[24:27], v[212:215]
    ds_read_b128 v[40:43], v5 offset:6144
    v_mfma_f32_16x16x32_bf16 v[8:11], v[28:31], a[44:47], v[8:11]
    buffer_load_dwordx4 v192, s[36:39], m0 offen offset:3072 sc1 lds
    v_cndmask_b32 v48, v49, v48, vcc
    v_mfma_f32_16x16x32_bf16 v[12:15], v[28:31], a[108:111], v[12:15]
    s_waitcnt lgkmcnt(1)
    ds_read_b128 v[44:47], v5 offset:7168
    v_mfma_f32_16x16x32_bf16 v[212:215], a[172:175], v[28:31], v[212:215]
    s_add_u32 m0, m0, 12288
    ds_read_b128 v[24:27], v5 offset:12288
    v_mfma_f32_16x16x32_bf16 v[8:11], v[32:35], a[16:19], v[8:11]
    ds_write_b32 v194, v48
    v_mfma_f32_16x16x32_bf16 v[12:15], v[32:35], a[80:83], v[12:15]
    v_mfma_f32_16x16x32_bf16 v[212:215], a[144:147], v[32:35], v[212:215]
    ds_read_b128 v[28:31], v5 offset:13312
    v_mfma_f32_16x16x32_bf16 v[8:11], v[36:39], a[20:23], v[8:11]
    buffer_load_dwordx4 v192, s[36:39], m0 offen offset:0 sc1 lds
    v_mfma_f32_16x16x32_bf16 v[12:15], v[36:39], a[84:87], v[12:15]
    s_waitcnt lgkmcnt(3)
    v_mfma_f32_16x16x32_bf16 v[212:215], a[148:151], v[36:39], v[212:215]
    ds_read_b128 v[32:35], v5 offset:14336
    v_mfma_f32_16x16x32_bf16 v[8:11], v[40:43], a[24:27], v[8:11]
    buffer_load_dwordx4 v192, s[36:39], m0 offen offset:1024 sc1 lds
    v_mfma_f32_16x16x32_bf16 v[12:15], v[40:43], a[88:91], v[12:15]
    v_mfma_f32_16x16x32_bf16 v[212:215], a[152:155], v[40:43], v[212:215]
    ds_read_b128 v[36:39], v5 offset:15360
    v_mfma_f32_16x16x32_bf16 v[8:11], v[44:47], a[28:31], v[8:11]
    v_mfma_f32_16x16x32_bf16 v[12:15], v[44:47], a[92:95], v[12:15]
    s_waitcnt lgkmcnt(2)
    v_mfma_f32_16x16x32_bf16 v[212:215], a[156:159], v[44:47], v[212:215]
    buffer_load_dwordx4 v192, s[36:39], m0 offen offset:2048 sc1 lds
    buffer_load_dwordx4 v192, s[36:39], m0 offen offset:3072 sc1 lds
    s_add_u32 m0, m0, 4096
    s_nop 0
    buffer_load_dwordx4 v192, s[36:39], m0 offen offset:0 sc1 lds
    buffer_load_dwordx4 v192, s[36:39], m0 offen offset:1024 sc1 lds
    s_waitcnt vmcnt(6)
    s_barrier
    ds_read_b128 v[40:43], v5 offset:16384
    v_mfma_f32_16x16x32_bf16 v[8:11], v[24:27], a[48:51], v[8:11]
    buffer_load_dwordx4 v192, s[36:39], m0 offen offset:2048 sc1 lds
    v_mfma_f32_16x16x32_bf16 v[12:15], v[24:27], a[112:115], v[12:15]
    ds_read_b128 v[48:51], v198 offset:0
    v_mfma_f32_16x16x32_bf16 v[212:215], a[176:179], v[24:27], v[212:215]
    ds_read_b128 v[44:47], v5 offset:17408
    v_mfma_f32_16x16x32_bf16 v[8:11], v[28:31], a[52:55], v[8:11]
    buffer_load_dwordx4 v192, s[36:39], m0 offen offset:3072 sc1 lds
    v_mfma_f32_16x16x32_bf16 v[12:15], v[28:31], a[116:119], v[12:15]
    s_waitcnt lgkmcnt(3)
    ds_read_b128 v[52:55], v198 offset:512
    v_mfma_f32_16x16x32_bf16 v[212:215], a[180:183], v[28:31], v[212:215]
    s_add_u32 m0, m0, 12288
    ds_read_b128 v[24:27], v5 offset:18432
    v_mfma_f32_16x16x32_bf16 v[8:11], v[32:35], a[56:59], v[8:11]
    ds_read_b32 v228, v193 offset:0
    v_mfma_f32_16x16x32_bf16 v[12:15], v[32:35], a[120:123], v[12:15]
    ds_read_b32 v229, v193 offset:512
    v_mfma_f32_16x16x32_bf16 v[212:215], a[184:187], v[32:35], v[212:215]
    ds_read_b128 v[28:31], v5 offset:19456
    v_mfma_f32_16x16x32_bf16 v[8:11], v[36:39], a[60:63], v[8:11]
    buffer_load_dwordx4 v192, s[36:39], m0 offen offset:0 sc1 lds
    v_mfma_f32_16x16x32_bf16 v[12:15], v[36:39], a[124:127], v[12:15]
    s_waitcnt lgkmcnt(5)
    ds_read_b32 v230, v193 offset:64
    v_mfma_f32_16x16x32_bf16 v[212:215], a[188:191], v[36:39], v[212:215]
    ds_read_b128 v[32:35], v5 offset:24576
    ds_read_b32 v231, v193 offset:576
    ds_read_b32 v232, v193 offset:128
    ds_read_b32 v233, v193 offset:640
    ds_read_b32 v234, v193 offset:192
    ds_read_b32 v235, v193 offset:704
    v_mfma_f32_16x16x32_bf16 v[16:19], v[40:43], a[0:3], 0
    buffer_load_dwordx4 v192, s[36:39], m0 offen offset:1024 sc1 lds
    v_mfma_f32_16x16x32_bf16 v[20:23], v[40:43], a[64:67], 0
    ds_read_b128 v[36:39], v5 offset:25600
    v_mfma_f32_16x16x32_bf16 v[16:19], v[44:47], a[4:7], v[16:19]
    s_waitcnt lgkmcnt(8)
    v_fma_f32 v8, -v48, v96, v8
    v_mfma_f32_16x16x32_bf16 v[20:23], v[44:47], a[68:71], v[20:23]
    ds_read_b128 v[40:43], v5 offset:26624
    v_fma_f32 v9, -v49, v96, v9
    v_mfma_f32_16x16x32_bf16 v[16:19], v[24:27], a[8:11], v[16:19]
    buffer_load_dwordx4 v192, s[36:39], m0 offen offset:2048 sc1 lds
    v_fma_f32 v10, -v50, v96, v10
    v_mfma_f32_16x16x32_bf16 v[20:23], v[24:27], a[72:75], v[20:23]
    ds_read_b128 v[44:47], v5 offset:27648
    v_fma_f32 v11, -v51, v96, v11
    v_mfma_f32_16x16x32_bf16 v[16:19], v[28:31], a[12:15], v[16:19]
    s_waitcnt lgkmcnt(2)
    v_fma_f32 v12, -v48, v97, v12
    v_fma_f32 v13, -v49, v97, v13
    v_mfma_f32_16x16x32_bf16 v[20:23], v[28:31], a[76:79], v[20:23]
    ds_read_b128 v[24:27], v5 offset:20480
    v_fma_f32 v14, -v50, v97, v14
    v_mfma_f32_16x16x32_bf16 v[16:19], v[32:35], a[32:35], v[16:19]
    buffer_load_dwordx4 v192, s[36:39], m0 offen offset:3072 sc1 lds
    v_fma_f32 v15, -v51, v97, v15
    v_mfma_f32_16x16x32_bf16 v[20:23], v[32:35], a[96:99], v[20:23]
    s_add_u32 m0, m0, 4096
    ds_read_b128 v[28:31], v5 offset:21504
    v_mul_f32 v8, v8, v52
    v_mfma_f32_16x16x32_bf16 v[16:19], v[36:39], a[36:39], v[16:19]
    s_waitcnt lgkmcnt(2)
    v_mul_f32 v9, v9, v53
    v_mul_f32 v10, v10, v54
    v_mfma_f32_16x16x32_bf16 v[20:23], v[36:39], a[100:103], v[20:23]
    ds_read_b128 v[32:35], v5 offset:22528
    v_mul_f32 v11, v11, v55
    v_mfma_f32_16x16x32_bf16 v[16:19], v[40:43], a[40:43], v[16:19]
    buffer_load_dwordx4 v192, s[36:39], m0 offen offset:0 sc1 lds
    v_mfma_f32_16x16x32_bf16 v[20:23], v[40:43], a[104:107], v[20:23]
    ds_read_b128 v[36:39], v5 offset:23552
    v_mfma_f32_16x16x32_bf16 v[16:19], v[44:47], a[44:47], v[16:19]
    s_waitcnt lgkmcnt(2)
    v_exp_f32 v56, v8 clamp
    v_mfma_f32_16x16x32_bf16 v[20:23], v[44:47], a[108:111], v[20:23]
    ds_read_b128 v[40:43], v5 offset:28672
    v_mul_f32 v12, v12, v52
    v_mfma_f32_16x16x32_bf16 v[16:19], v[24:27], a[16:19], v[16:19]
    buffer_load_dwordx4 v192, s[36:39], m0 offen offset:1024 sc1 lds
    v_mfma_f32_16x16x32_bf16 v[20:23], v[24:27], a[80:83], v[20:23]
    ds_read_b128 v[44:47], v5 offset:29696
    v_mfma_f32_16x16x32_bf16 v[16:19], v[28:31], a[20:23], v[16:19]
    s_waitcnt lgkmcnt(2)
    v_exp_f32 v57, v9 clamp
    v_mfma_f32_16x16x32_bf16 v[20:23], v[28:31], a[84:87], v[20:23]
    ds_read_b128 v[24:27], v5 offset:30720
    v_mul_f32 v13, v13, v53
    v_mfma_f32_16x16x32_bf16 v[16:19], v[32:35], a[24:27], v[16:19]
    buffer_load_dwordx4 v192, s[36:39], m0 offen offset:2048 sc1 lds
    v_mfma_f32_16x16x32_bf16 v[20:23], v[32:35], a[88:91], v[20:23]
    ds_read_b128 v[28:31], v5 offset:31744
    v_mfma_f32_16x16x32_bf16 v[16:19], v[36:39], a[28:31], v[16:19]
    s_waitcnt lgkmcnt(2)
    v_exp_f32 v58, v10 clamp
    v_mfma_f32_16x16x32_bf16 v[20:23], v[36:39], a[92:95], v[20:23]
    s_waitcnt vmcnt(7)
    s_barrier
    ds_read_b128 v[32:35], v5 offset:32768
    v_mul_f32 v14, v14, v54
    v_mfma_f32_16x16x32_bf16 v[16:19], v[40:43], a[48:51], v[16:19]
    buffer_load_dwordx4 v192, s[36:39], m0 offen offset:3072 sc1 lds
    v_mfma_f32_16x16x32_bf16 v[20:23], v[40:43], a[112:115], v[20:23]
    ds_read_b128 v[36:39], v5 offset:33792
    v_mfma_f32_16x16x32_bf16 v[16:19], v[44:47], a[52:55], v[16:19]
    s_waitcnt lgkmcnt(2)
    v_exp_f32 v59, v11 clamp
    v_mfma_f32_16x16x32_bf16 v[20:23], v[44:47], a[116:119], v[20:23]
    ds_read_b128 v[40:43], v5 offset:34816
    v_mul_f32 v15, v15, v55
    v_mfma_f32_16x16x32_bf16 v[16:19], v[24:27], a[56:59], v[16:19]
    v_fma_f32 v8, v8, v84, s91
    v_fma_f32 v9, v9, v84, s91
    v_mfma_f32_16x16x32_bf16 v[20:23], v[24:27], a[120:123], v[20:23]
    ds_read_b128 v[44:47], v5 offset:35840
    v_fma_f32 v10, v10, v84, s91
    v_mfma_f32_16x16x32_bf16 v[16:19], v[28:31], a[60:63], v[16:19]
    s_waitcnt lgkmcnt(2)
    v_fma_f32 v11, v11, v84, s91
    v_mfma_f32_16x16x32_bf16 v[20:23], v[28:31], a[124:127], v[20:23]
    ds_read_b128 v[24:27], v5 offset:40960
    ds_read_b128 v[48:51], v198 offset:64
    v_add_f32 v56, s92, v56
    v_add_f32 v57, s92, v57
    v_add_f32 v58, s92, v58
    v_add_f32 v59, s92, v59
    ds_read_b128 v[52:55], v198 offset:576
    v_max_f32 v8, v8, v56
    v_max_f32 v9, v9, v57
    v_max_f32 v10, v10, v58
    v_max_f32 v11, v11, v59
    v_cvt_pk_bf16_f32 v64, v12, v13
    v_cvt_pk_bf16_f32 v65, v14, v15
    v_cvt_pk_bf16_f32 v60, v8, v9
    v_cvt_pk_bf16_f32 v61, v10, v11
    v_mfma_f32_16x16x32_bf16 v[8:11], v[32:35], a[0:3], 0
    v_mfma_f32_16x16x32_bf16 v[12:15], v[32:35], a[64:67], 0
    ds_read_b128 v[28:31], v5 offset:41984
    v_mfma_f32_16x16x32_bf16 v[8:11], v[36:39], a[4:7], v[8:11]
    s_waitcnt lgkmcnt(4)
    s_waitcnt lgkmcnt(2)
    v_fma_f32 v16, -v48, v96, v16
    v_fma_f32 v17, -v49, v96, v17
    v_mfma_f32_16x16x32_bf16 v[12:15], v[36:39], a[68:71], v[12:15]
    ds_read_b128 v[32:35], v5 offset:43008
    v_fma_f32 v18, -v50, v96, v18
    v_mfma_f32_16x16x32_bf16 v[8:11], v[40:43], a[8:11], v[8:11]
    v_fma_f32 v19, -v51, v96, v19
    v_fma_f32 v20, -v48, v97, v20
    v_mfma_f32_16x16x32_bf16 v[12:15], v[40:43], a[72:75], v[12:15]
    ds_read_b128 v[36:39], v5 offset:44032
    v_fma_f32 v21, -v49, v97, v21
    v_mfma_f32_16x16x32_bf16 v[8:11], v[44:47], a[12:15], v[8:11]
    s_waitcnt lgkmcnt(2)
    v_fma_f32 v22, -v50, v97, v22
    v_fma_f32 v23, -v51, v97, v23
    v_mfma_f32_16x16x32_bf16 v[12:15], v[44:47], a[76:79], v[12:15]
    ds_read_b128 v[40:43], v5 offset:36864
    v_mul_f32 v16, v16, v52
    v_mfma_f32_16x16x32_bf16 v[8:11], v[24:27], a[32:35], v[8:11]
    v_mul_f32 v17, v17, v53
    v_mul_f32 v18, v18, v54
    v_mfma_f32_16x16x32_bf16 v[12:15], v[24:27], a[96:99], v[12:15]
    ds_read_b128 v[44:47], v5 offset:37888
    v_mul_f32 v19, v19, v55
    v_mfma_f32_16x16x32_bf16 v[8:11], v[28:31], a[36:39], v[8:11]
    s_waitcnt lgkmcnt(2)
    v_exp_f32 v56, v16 clamp
    v_mfma_f32_16x16x32_bf16 v[12:15], v[28:31], a[100:103], v[12:15]
    ds_read_b128 v[24:27], v5 offset:38912
    v_mul_f32 v20, v20, v52
    v_mfma_f32_16x16x32_bf16 v[8:11], v[32:35], a[40:43], v[8:11]
    v_exp_f32 v57, v17 clamp
    v_mfma_f32_16x16x32_bf16 v[12:15], v[32:35], a[104:107], v[12:15]
    ds_read_b128 v[28:31], v5 offset:39936
    v_mul_f32 v21, v21, v53
    v_mfma_f32_16x16x32_bf16 v[8:11], v[36:39], a[44:47], v[8:11]
    s_waitcnt lgkmcnt(2)
    v_exp_f32 v58, v18 clamp
    v_mfma_f32_16x16x32_bf16 v[12:15], v[36:39], a[108:111], v[12:15]
    ds_read_b128 v[32:35], v5 offset:45056
    v_mul_f32 v22, v22, v54
    v_mfma_f32_16x16x32_bf16 v[8:11], v[40:43], a[16:19], v[8:11]
    v_exp_f32 v59, v19 clamp
    v_mfma_f32_16x16x32_bf16 v[12:15], v[40:43], a[80:83], v[12:15]
    ds_read_b128 v[36:39], v5 offset:46080
    v_mul_f32 v23, v23, v55
    v_mfma_f32_16x16x32_bf16 v[8:11], v[44:47], a[20:23], v[8:11]
    s_waitcnt lgkmcnt(2)
    v_fma_f32 v16, v16, v84, s91
    v_fma_f32 v17, v17, v84, s91
    v_mfma_f32_16x16x32_bf16 v[12:15], v[44:47], a[84:87], v[12:15]
    ds_read_b128 v[40:43], v5 offset:47104
    v_fma_f32 v18, v18, v84, s91
    v_mfma_f32_16x16x32_bf16 v[8:11], v[24:27], a[24:27], v[8:11]
    v_fma_f32 v19, v19, v84, s91
    v_mfma_f32_16x16x32_bf16 v[12:15], v[24:27], a[88:91], v[12:15]
    ds_read_b128 v[44:47], v5 offset:48128
    v_mfma_f32_16x16x32_bf16 v[8:11], v[28:31], a[28:31], v[8:11]
    s_waitcnt lgkmcnt(2)
    ds_read_b128 v[48:51], v198 offset:128
    v_add_f32 v56, s92, v56
    v_mfma_f32_16x16x32_bf16 v[12:15], v[28:31], a[92:95], v[12:15]
    s_waitcnt vmcnt(0)
    s_barrier
    ds_read_b128 v[24:27], v5 offset:49152
    v_add_f32 v57, s92, v57
    v_mfma_f32_16x16x32_bf16 v[8:11], v[32:35], a[48:51], v[8:11]
    v_add_f32 v58, s92, v58
    v_add_f32 v59, s92, v59
    v_mfma_f32_16x16x32_bf16 v[12:15], v[32:35], a[112:115], v[12:15]
    ds_read_b128 v[28:31], v5 offset:50176
    v_mfma_f32_16x16x32_bf16 v[8:11], v[36:39], a[52:55], v[8:11]
    s_waitcnt lgkmcnt(3)
    ds_read_b128 v[52:55], v198 offset:640
    v_max_f32 v16, v16, v56
    v_mfma_f32_16x16x32_bf16 v[12:15], v[36:39], a[116:119], v[12:15]
    ds_read_b128 v[32:35], v5 offset:51200
    v_max_f32 v17, v17, v57
    v_mfma_f32_16x16x32_bf16 v[8:11], v[40:43], a[56:59], v[8:11]
    v_max_f32 v18, v18, v58
    v_max_f32 v19, v19, v59
    v_mfma_f32_16x16x32_bf16 v[12:15], v[40:43], a[120:123], v[12:15]
    ds_read_b128 v[36:39], v5 offset:52224
    v_cvt_pk_bf16_f32 v66, v20, v21
    v_mfma_f32_16x16x32_bf16 v[8:11], v[44:47], a[60:63], v[8:11]
    s_waitcnt lgkmcnt(3)
    v_cvt_pk_bf16_f32 v67, v22, v23
    v_cvt_pk_bf16_f32 v62, v16, v17
    v_mfma_f32_16x16x32_bf16 v[12:15], v[44:47], a[124:127], v[12:15]
    ds_read_b128 v[40:43], v5 offset:57344
    v_cvt_pk_bf16_f32 v63, v18, v19
    s_nop 1
    v_mfma_f32_16x16x32_bf16 v[68:71], v[60:63], v[64:67], 0
    v_mfma_f32_16x16x32_bf16 v[72:75], v[60:63], v[100:103], 0
    v_mfma_f32_16x16x32_bf16 v[16:19], v[24:27], a[0:3], 0
    s_lshl_b32 s80, s53, 1
    v_mfma_f32_16x16x32_bf16 v[20:23], v[24:27], a[64:67], 0
    s_and_b32 s81, s46, 1
    ds_read_b128 v[44:47], v5 offset:58368
    v_mfma_f32_16x16x32_bf16 v[16:19], v[28:31], a[4:7], v[16:19]
    s_waitcnt lgkmcnt(2)
    v_fma_f32 v8, -v48, v96, v8
    v_fma_f32 v9, -v49, v96, v9
    v_mfma_f32_16x16x32_bf16 v[20:23], v[28:31], a[68:71], v[20:23]
    s_add_u32 s66, s80, s81
    ds_read_b128 v[24:27], v5 offset:59392
    v_fma_f32 v10, -v50, v96, v10
    v_mfma_f32_16x16x32_bf16 v[16:19], v[32:35], a[8:11], v[16:19]
    s_lshl_b32 s80, s66, 4
    v_fma_f32 v11, -v51, v96, v11
    v_fma_f32 v12, -v48, v97, v12
    v_mfma_f32_16x16x32_bf16 v[20:23], v[32:35], a[72:75], v[20:23]
    s_add_u32 s80, s80, s52
    ds_read_b128 v[28:31], v5 offset:60416
    v_fma_f32 v13, -v49, v97, v13
    v_mfma_f32_16x16x32_bf16 v[16:19], v[36:39], a[12:15], v[16:19]
    s_waitcnt lgkmcnt(2)
    v_fma_f32 v14, -v50, v97, v14
    v_fma_f32 v15, -v51, v97, v15
    v_mfma_f32_16x16x32_bf16 v[20:23], v[36:39], a[76:79], v[20:23]
    s_lshl_b32 s64, s80, 9
    ds_read_b128 v[32:35], v5 offset:53248
    v_mul_f32 v8, v8, v52
    v_mfma_f32_16x16x32_bf16 v[16:19], v[40:43], a[32:35], v[16:19]
    s_add_u32 s64, s64, 589824
    v_mul_f32 v9, v9, v53
    v_mul_f32 v10, v10, v54
    v_mfma_f32_16x16x32_bf16 v[20:23], v[40:43], a[96:99], v[20:23]
    s_lshl_b32 s65, s80, 6
    ds_read_b128 v[36:39], v5 offset:54272
    v_mul_f32 v11, v11, v55
    v_mfma_f32_16x16x32_bf16 v[16:19], v[44:47], a[36:39], v[16:19]
    s_waitcnt lgkmcnt(2)
    v_exp_f32 v56, v8 clamp
    v_mfma_f32_16x16x32_bf16 v[20:23], v[44:47], a[100:103], v[20:23]
    s_add_u32 s65, s65, 851968
    ds_read_b128 v[40:43], v5 offset:55296
    v_mul_f32 v12, v12, v52
    v_mfma_f32_16x16x32_bf16 v[16:19], v[24:27], a[40:43], v[16:19]
    v_exp_f32 v57, v9 clamp
    v_mfma_f32_16x16x32_bf16 v[20:23], v[24:27], a[104:107], v[20:23]
    ds_read_b128 v[44:47], v5 offset:56320
    v_mul_f32 v13, v13, v53
    v_mfma_f32_16x16x32_bf16 v[16:19], v[28:31], a[44:47], v[16:19]
    s_waitcnt lgkmcnt(2)
    v_exp_f32 v58, v10 clamp
    v_mfma_f32_16x16x32_bf16 v[20:23], v[28:31], a[108:111], v[20:23]
    ds_read_b128 v[24:27], v5 offset:61440
    v_mul_f32 v14, v14, v54
    v_mfma_f32_16x16x32_bf16 v[16:19], v[32:35], a[16:19], v[16:19]
    v_exp_f32 v59, v11 clamp
    v_mfma_f32_16x16x32_bf16 v[20:23], v[32:35], a[80:83], v[20:23]
    ds_read_b128 v[28:31], v5 offset:62464
    v_mul_f32 v15, v15, v55
    v_mfma_f32_16x16x32_bf16 v[16:19], v[36:39], a[20:23], v[16:19]
    s_waitcnt lgkmcnt(2)
    v_fma_f32 v8, v8, v84, s91
    v_fma_f32 v9, v9, v84, s91
    v_mfma_f32_16x16x32_bf16 v[20:23], v[36:39], a[84:87], v[20:23]
    ds_read_b128 v[32:35], v5 offset:63488
    v_fma_f32 v10, v10, v84, s91
    v_mfma_f32_16x16x32_bf16 v[16:19], v[40:43], a[24:27], v[16:19]
    v_fma_f32 v11, v11, v84, s91
    v_mfma_f32_16x16x32_bf16 v[20:23], v[40:43], a[88:91], v[20:23]
    ds_read_b128 v[36:39], v5 offset:64512
    v_mfma_f32_16x16x32_bf16 v[16:19], v[44:47], a[28:31], v[16:19]
    s_waitcnt lgkmcnt(2)
    ds_read_b128 v[48:51], v198 offset:192
    v_add_f32 v56, s92, v56
    v_mfma_f32_16x16x32_bf16 v[20:23], v[44:47], a[92:95], v[20:23]
    ds_read_b128 v[40:43], v5 offset:16384
    v_add_f32 v57, s92, v57
    v_mfma_f32_16x16x32_bf16 v[16:19], v[24:27], a[48:51], v[16:19]
    v_add_f32 v58, s92, v58
    v_add_f32 v59, s92, v59
    v_mfma_f32_16x16x32_bf16 v[20:23], v[24:27], a[112:115], v[20:23]
    ds_read_b128 v[44:47], v5 offset:17408
    v_mfma_f32_16x16x32_bf16 v[16:19], v[28:31], a[52:55], v[16:19]
    s_waitcnt lgkmcnt(3)
    ds_read_b128 v[52:55], v198 offset:704
    v_max_f32 v8, v8, v56
    v_mfma_f32_16x16x32_bf16 v[20:23], v[28:31], a[116:119], v[20:23]
    ds_read_b128 v[24:27], v5 offset:18432
    v_max_f32 v9, v9, v57
    v_mfma_f32_16x16x32_bf16 v[16:19], v[32:35], a[56:59], v[16:19]
    v_max_f32 v10, v10, v58
    v_max_f32 v11, v11, v59
    v_mfma_f32_16x16x32_bf16 v[20:23], v[32:35], a[120:123], v[20:23]
    ds_read_b128 v[28:31], v5 offset:19456
    v_cvt_pk_bf16_f32 v64, v12, v13
    v_mfma_f32_16x16x32_bf16 v[16:19], v[36:39], a[60:63], v[16:19]
    v_cvt_pk_bf16_f32 v65, v14, v15
    v_cvt_pk_bf16_f32 v60, v8, v9
    v_mfma_f32_16x16x32_bf16 v[20:23], v[36:39], a[124:127], v[20:23]
    ds_read_b128 v[32:35], v5 offset:24576
    v_cvt_pk_bf16_f32 v61, v10, v11
    s_cmp_lt_u32 s46, 2
    s_cselect_b32 s64, s64, 0x40000000
    s_cselect_b32 s65, 0x40000000, s65
    s_cselect_b64 vcc, -1, 0
    s_waitcnt lgkmcnt(6)
    v_pk_fma_f32 v[16:17], v[48:49], v[96:97], v[16:17] op_sel_hi:[1,0,1] neg_lo:[1,0,0] neg_hi:[1,0,0]
    v_pk_fma_f32 v[18:19], v[50:51], v[96:97], v[18:19] op_sel_hi:[1,0,1] neg_lo:[1,0,0] neg_hi:[1,0,0]
    s_waitcnt lgkmcnt(3)
    v_pk_mul_f32 v[16:17], v[16:17], v[52:53]
    v_pk_mul_f32 v[18:19], v[18:19], v[54:55]
    v_exp_f32 v56, v16 clamp
    v_exp_f32 v57, v17 clamp
    v_exp_f32 v58, v18 clamp
    v_exp_f32 v59, v19 clamp
    v_pk_fma_f32 v[20:21], v[48:49], v[96:97], v[20:21] op_sel:[0,1,0] op_sel_hi:[1,1,1] neg_lo:[1,0,0] neg_hi:[1,0,0]
    v_pk_fma_f32 v[22:23], v[50:51], v[96:97], v[22:23] op_sel:[0,1,0] op_sel_hi:[1,1,1] neg_lo:[1,0,0] neg_hi:[1,0,0]
    v_pk_mul_f32 v[20:21], v[20:21], v[52:53]
    v_pk_mul_f32 v[22:23], v[22:23], v[54:55]
    v_pk_fma_f32 v[16:17], v[16:17], v[84:85], v[84:85] op_sel:[0,0,1] op_sel_hi:[1,0,1]
    v_pk_fma_f32 v[18:19], v[18:19], v[84:85], v[84:85] op_sel:[0,0,1] op_sel_hi:[1,0,1]
    v_pk_add_f32 v[56:57], v[56:57], s[92:93] op_sel_hi:[1,0]
    v_pk_add_f32 v[58:59], v[58:59], s[92:93] op_sel_hi:[1,0]
    v_max_f32 v16, v16, v56
    v_max_f32 v17, v17, v57
    v_max_f32 v18, v18, v58
    v_max_f32 v19, v19, v59
    v_cvt_pk_bf16_f32 v66, v20, v21
    v_cvt_pk_bf16_f32 v67, v22, v23
    v_cvt_pk_bf16_f32 v62, v16, v17
    v_cvt_pk_bf16_f32 v63, v18, v19
    s_nop 1
    v_mfma_f32_16x16x32_bf16 v[68:71], v[60:63], v[64:67], v[68:71]
    v_mfma_f32_16x16x32_bf16 v[72:75], v[60:63], v[100:103], v[72:75]
    s_nop 7
    v_cndmask_b32 v8, v68, v72, vcc
    v_cndmask_b32 v9, v69, v73, vcc
    v_cndmask_b32 v10, v70, v74, vcc
    v_cndmask_b32 v11, v71, v75, vcc
    ds_write_b128 v4, v[8:11]
    v_cndmask_b32 v68, v72, v68, vcc
    v_cndmask_b32 v69, v73, v69, vcc
    v_cndmask_b32 v70, v74, v70, vcc
    v_cndmask_b32 v71, v75, v71, vcc
    s_waitcnt lgkmcnt(0)
    s_barrier
    ds_read_b128 v[12:15], v209
    s_waitcnt lgkmcnt(0)
    v_pk_add_f32 v[68:69], v[68:69], v[12:13]
    v_pk_add_f32 v[70:71], v[70:71], v[14:15]
    buffer_store_dwordx4 v[68:71], v211, s[4:7], s65 offen sc1
    v_pk_mul_f32 v[8:9], v[68:69], v[84:85] op_sel_hi:[1,0]
    v_pk_mul_f32 v[10:11], v[70:71], v[84:85] op_sel_hi:[1,0]
    v_cvt_pk_bf16_f32 v64, v8, v9
    v_cvt_pk_bf16_f32 v65, v10, v11
    buffer_store_dwordx2 v[64:65], v83, s[4:7], s64 offen sc1
    s_cmp_lg_u32 s49, 0
    s_cbranch_scc1 L_ool64
L_back65:
    s_mov_b64 exec, 1
    buffer_store_dword v98, v87, s[4:7], s72 offen
    s_mov_b64 exec, -1
    v_mfma_f32_16x16x32_bf16 v[216:219], a[128:131], v[40:43], 0
    s_lshl_b32 s64, s66, 13
    ds_read_b128 v[36:39], v5 offset:25600
    v_mfma_f32_16x16x32_bf16 v[216:219], a[132:135], v[44:47], v[216:219]
    s_add_u32 s64, s64, 589824
    ds_read_b128 v[40:43], v5 offset:26624
    v_mfma_f32_16x16x32_bf16 v[216:219], a[136:139], v[24:27], v[216:219]
    s_add_u32 s65, s64, 4096
    ds_read_b128 v[44:47], v5 offset:27648
    v_mfma_f32_16x16x32_bf16 v[216:219], a[140:143], v[28:31], v[216:219]
    s_lshl_b32 s42, s66, 10
    ds_read_b128 v[24:27], v5 offset:20480
    v_mfma_f32_16x16x32_bf16 v[216:219], a[160:163], v[32:35], v[216:219]
    s_waitcnt lgkmcnt(3)
    ds_read_b128 v[28:31], v5 offset:21504
    v_mfma_f32_16x16x32_bf16 v[216:219], a[164:167], v[36:39], v[216:219]
    s_waitcnt lgkmcnt(3)
    ds_read_b128 v[32:35], v5 offset:22528
    v_mfma_f32_16x16x32_bf16 v[216:219], a[168:171], v[40:43], v[216:219]
    s_waitcnt lgkmcnt(3)
    ds_read_b128 v[36:39], v5 offset:23552
    v_mfma_f32_16x16x32_bf16 v[216:219], a[172:175], v[44:47], v[216:219]
    s_waitcnt lgkmcnt(3)
    ds_read_b128 v[40:43], v5 offset:28672
    v_mfma_f32_16x16x32_bf16 v[216:219], a[144:147], v[24:27], v[216:219]
    s_waitcnt lgkmcnt(3)
    ds_read_b128 v[44:47], v5 offset:29696
    v_mfma_f32_16x16x32_bf16 v[216:219], a[148:151], v[28:31], v[216:219]
    s_waitcnt lgkmcnt(3)
    ds_read_b128 v[24:27], v5 offset:30720
    v_mfma_f32_16x16x32_bf16 v[216:219], a[152:155], v[32:35], v[216:219]
    s_waitcnt lgkmcnt(3)
    ds_read_b128 v[28:31], v5 offset:31744
    v_mfma_f32_16x16x32_bf16 v[216:219], a[156:159], v[36:39], v[216:219]
    s_waitcnt lgkmcnt(3)
    ds_read_b128 v[32:35], v5 offset:32768
    v_mfma_f32_16x16x32_bf16 v[216:219], a[176:179], v[40:43], v[216:219]
    s_waitcnt lgkmcnt(3)
    ds_read_b128 v[36:39], v5 offset:33792
    v_mfma_f32_16x16x32_bf16 v[216:219], a[180:183], v[44:47], v[216:219]
    s_waitcnt lgkmcnt(3)
    ds_read_b128 v[40:43], v5 offset:34816
    v_mfma_f32_16x16x32_bf16 v[216:219], a[184:187], v[24:27], v[216:219]
    s_waitcnt lgkmcnt(3)
    ds_read_b128 v[44:47], v5 offset:35840
    v_mfma_f32_16x16x32_bf16 v[216:219], a[188:191], v[28:31], v[216:219]
    s_waitcnt lgkmcnt(3)
    ds_read_b128 v[24:27], v5 offset:40960
    v_mfma_f32_16x16x32_bf16 v[220:223], a[128:131], v[32:35], 0
    s_waitcnt lgkmcnt(3)
    ds_read_b128 v[28:31], v5 offset:41984
    v_mfma_f32_16x16x32_bf16 v[220:223], a[132:135], v[36:39], v[220:223]
    s_waitcnt lgkmcnt(3)
    ds_read_b128 v[32:35], v5 offset:43008
    v_mfma_f32_16x16x32_bf16 v[220:223], a[136:139], v[40:43], v[220:223]
    s_waitcnt lgkmcnt(3)
    ds_read_b128 v[36:39], v5 offset:44032
    v_mfma_f32_16x16x32_bf16 v[220:223], a[140:143], v[44:47], v[220:223]
    s_waitcnt lgkmcnt(3)
    ds_read_b128 v[40:43], v5 offset:36864
    v_mfma_f32_16x16x32_bf16 v[220:223], a[160:163], v[24:27], v[220:223]
    s_waitcnt lgkmcnt(3)
    ds_read_b128 v[44:47], v5 offset:37888
    v_mfma_f32_16x16x32_bf16 v[220:223], a[164:167], v[28:31], v[220:223]
    s_waitcnt lgkmcnt(3)
    ds_read_b128 v[24:27], v5 offset:38912
    v_mfma_f32_16x16x32_bf16 v[220:223], a[168:171], v[32:35], v[220:223]
    s_waitcnt lgkmcnt(3)
    ds_read_b128 v[28:31], v5 offset:39936
    v_mfma_f32_16x16x32_bf16 v[220:223], a[172:175], v[36:39], v[220:223]
    s_waitcnt lgkmcnt(3)
    ds_read_b128 v[32:35], v5 offset:45056
    v_mfma_f32_16x16x32_bf16 v[220:223], a[144:147], v[40:43], v[220:223]
    s_waitcnt lgkmcnt(3)
    ds_read_b128 v[36:39], v5 offset:46080
    v_mfma_f32_16x16x32_bf16 v[220:223], a[148:151], v[44:47], v[220:223]
    s_waitcnt lgkmcnt(3)
    ds_read_b128 v[40:43], v5 offset:47104
    v_mfma_f32_16x16x32_bf16 v[220:223], a[152:155], v[24:27], v[220:223]
    s_waitcnt lgkmcnt(3)
    ds_read_b128 v[44:47], v5 offset:48128
    v_mfma_f32_16x16x32_bf16 v[220:223], a[156:159], v[28:31], v[220:223]
    s_waitcnt lgkmcnt(3)
    ds_read_b128 v[24:27], v5 offset:49152
    v_mfma_f32_16x16x32_bf16 v[220:223], a[176:179], v[32:35], v[220:223]
    s_waitcnt lgkmcnt(3)
    ds_read_b128 v[28:31], v5 offset:50176
    v_mfma_f32_16x16x32_bf16 v[220:223], a[180:183], v[36:39], v[220:223]
    s_waitcnt lgkmcnt(3)
    ds_read_b128 v[32:35], v5 offset:51200
    v_mfma_f32_16x16x32_bf16 v[220:223], a[184:187], v[40:43], v[220:223]
    s_waitcnt lgkmcnt(3)
    ds_read_b128 v[36:39], v5 offset:52224
    v_mfma_f32_16x16x32_bf16 v[220:223], a[188:191], v[44:47], v[220:223]
    s_waitcnt lgkmcnt(3)
    ds_read_b128 v[40:43], v5 offset:57344
    v_mfma_f32_16x16x32_bf16 v[224:227], a[128:131], v[24:27], 0
    s_waitcnt lgkmcnt(3)
    ds_read_b128 v[44:47], v5 offset:58368
    v_mfma_f32_16x16x32_bf16 v[224:227], a[132:135], v[28:31], v[224:227]
    s_waitcnt lgkmcnt(3)
    ds_read_b128 v[24:27], v5 offset:59392
    v_mfma_f32_16x16x32_bf16 v[224:227], a[136:139], v[32:35], v[224:227]
    s_waitcnt lgkmcnt(3)
    ds_read_b128 v[28:31], v5 offset:60416
    v_mfma_f32_16x16x32_bf16 v[224:227], a[140:143], v[36:39], v[224:227]
    s_waitcnt lgkmcnt(3)
    ds_read_b128 v[32:35], v5 offset:53248
    v_mfma_f32_16x16x32_bf16 v[224:227], a[160:163], v[40:43], v[224:227]
    s_waitcnt lgkmcnt(3)
    ds_read_b128 v[36:39], v5 offset:54272
    v_mfma_f32_16x16x32_bf16 v[224:227], a[164:167], v[44:47], v[224:227]
    s_waitcnt lgkmcnt(3)
    ds_read_b128 v[40:43], v5 offset:55296
    v_mfma_f32_16x16x32_bf16 v[224:227], a[168:171], v[24:27], v[224:227]
    s_waitcnt lgkmcnt(3)
    ds_read_b128 v[44:47], v5 offset:56320
    v_mfma_f32_16x16x32_bf16 v[224:227], a[172:175], v[28:31], v[224:227]
    s_waitcnt lgkmcnt(3)
    ds_read_b128 v[24:27], v5 offset:61440
    v_mfma_f32_16x16x32_bf16 v[224:227], a[144:147], v[32:35], v[224:227]
    s_waitcnt lgkmcnt(3)
    ds_read_b128 v[28:31], v5 offset:62464
    v_mfma_f32_16x16x32_bf16 v[224:227], a[148:151], v[36:39], v[224:227]
    s_waitcnt lgkmcnt(3)
    ds_read_b128 v[32:35], v5 offset:63488
    v_mfma_f32_16x16x32_bf16 v[224:227], a[152:155], v[40:43], v[224:227]
    s_waitcnt lgkmcnt(3)
    ds_read_b128 v[36:39], v5 offset:64512
    v_mfma_f32_16x16x32_bf16 v[224:227], a[156:159], v[44:47], v[224:227]
    s_waitcnt lgkmcnt(3)
    v_mfma_f32_16x16x32_bf16 v[224:227], a[176:179], v[24:27], v[224:227]
    s_waitcnt lgkmcnt(2)
    v_mfma_f32_16x16x32_bf16 v[224:227], a[180:183], v[28:31], v[224:227]
    s_waitcnt lgkmcnt(1)
    v_mfma_f32_16x16x32_bf16 v[224:227], a[184:187], v[32:35], v[224:227]
    s_waitcnt lgkmcnt(0)
    v_mfma_f32_16x16x32_bf16 v[224:227], a[188:191], v[36:39], v[224:227]
    s_add_u32 s42, s42, 851968
    s_and_b32 s58, s46, 1
    s_lshl_b32 s71, s52, 8
    s_add_u32 s69, s71, 20480
    s_add_u32 s71, s71, 32768
    s_lshl_b32 s59, s53, 1
    s_add_u32 s58, s58, s59
    s_lshl_b32 s67, s58, 10
    s_lshl_b32 s58, s58, 2
    s_add_u32 s69, s69, s58
    s_lshr_b32 s58, s46, 1
    s_lshl_b32 s59, s58, 7
    s_add_u32 s69, s69, s59
    s_lshl_b32 s59, s52, 1
    s_add_u32 s58, s58, s59
    s_lshl_b32 s58, s58, 16
    s_add_u32 s67, s67, s58
    s_add_u32 s67, s67, 0
    s_add_u32 s68, s67, 0x8000
    v_pk_fma_f32 v[212:213], v[228:229], v[88:89], v[212:213] op_sel_hi:[0,1,1] neg_lo:[1,0,0] neg_hi:[1,0,0]
    v_pk_fma_f32 v[214:215], v[228:229], v[90:91], v[214:215] op_sel_hi:[0,1,1] neg_lo:[1,0,0] neg_hi:[1,0,0]
    v_pk_mul_f32 v[212:213], v[212:213], v[228:229] op_sel:[0,1] op_sel_hi:[1,1]
    v_pk_mul_f32 v[214:215], v[214:215], v[228:229] op_sel:[0,1] op_sel_hi:[1,1]
    v_exp_f32 v56, v212 clamp
    v_exp_f32 v57, v213 clamp
    v_exp_f32 v58, v214 clamp
    v_exp_f32 v59, v215 clamp
    v_pk_fma_f32 v[212:213], v[212:213], v[84:85], v[84:85] op_sel:[0,0,1] op_sel_hi:[1,0,1]
    v_pk_fma_f32 v[214:215], v[214:215], v[84:85], v[84:85] op_sel:[0,0,1] op_sel_hi:[1,0,1]
    v_pk_add_f32 v[56:57], v[56:57], s[92:93] op_sel_hi:[1,0]
    v_pk_add_f32 v[58:59], v[58:59], s[92:93] op_sel_hi:[1,0]
    v_max_f32 v212, v212, v56
    v_max_f32 v213, v213, v57
    v_max_f32 v214, v214, v58
    v_max_f32 v215, v215, v59
    v_cvt_pk_bf16_f32 v200, v212, v213
    v_cvt_pk_bf16_f32 v201, v214, v215
    v_pk_fma_f32 v[216:217], v[230:231], v[88:89], v[216:217] op_sel_hi:[0,1,1] neg_lo:[1,0,0] neg_hi:[1,0,0]
    v_pk_fma_f32 v[218:219], v[230:231], v[90:91], v[218:219] op_sel_hi:[0,1,1] neg_lo:[1,0,0] neg_hi:[1,0,0]
    v_pk_mul_f32 v[216:217], v[216:217], v[230:231] op_sel:[0,1] op_sel_hi:[1,1]
    v_pk_mul_f32 v[218:219], v[218:219], v[230:231] op_sel:[0,1] op_sel_hi:[1,1]
    v_exp_f32 v56, v216 clamp
    v_exp_f32 v57, v217 clamp
    v_exp_f32 v58, v218 clamp
    v_exp_f32 v59, v219 clamp
    v_pk_fma_f32 v[216:217], v[216:217], v[84:85], v[84:85] op_sel:[0,0,1] op_sel_hi:[1,0,1]
    v_pk_fma_f32 v[218:219], v[218:219], v[84:85], v[84:85] op_sel:[0,0,1] op_sel_hi:[1,0,1]
    v_pk_add_f32 v[56:57], v[56:57], s[92:93] op_sel_hi:[1,0]
    v_pk_add_f32 v[58:59], v[58:59], s[92:93] op_sel_hi:[1,0]
    v_max_f32 v216, v216, v56
    v_max_f32 v217, v217, v57
    v_max_f32 v218, v218, v58
    v_max_f32 v219, v219, v59
    v_cvt_pk_bf16_f32 v202, v216, v217
    v_cvt_pk_bf16_f32 v203, v218, v219
    v_pk_fma_f32 v[220:221], v[232:233], v[88:89], v[220:221] op_sel_hi:[0,1,1] neg_lo:[1,0,0] neg_hi:[1,0,0]
    v_pk_fma_f32 v[222:223], v[232:233], v[90:91], v[222:223] op_sel_hi:[0,1,1] neg_lo:[1,0,0] neg_hi:[1,0,0]
    v_pk_mul_f32 v[220:221], v[220:221], v[232:233] op_sel:[0,1] op_sel_hi:[1,1]
    v_pk_mul_f32 v[222:223], v[222:223], v[232:233] op_sel:[0,1] op_sel_hi:[1,1]
    buffer_load_dword v80, v210, s[4:7], s71 offen sc1
    buffer_load_dwordx4 v[40:43], v208, s[4:7], s42 offen sc1
    buffer_load_dwordx4 v[8:11], v1, s[4:7], s64 offen offset:0 sc1
    buffer_load_dwordx4 v[12:15], v1, s[4:7], s64 offen offset:1024 sc1
    buffer_load_dwordx4 v[16:19], v1, s[4:7], s64 offen offset:2048 sc1
    buffer_load_dwordx4 v[20:23], v1, s[4:7], s64 offen offset:3072 sc1
    buffer_load_dwordx4 v[24:27], v1, s[4:7], s65 offen offset:0 sc1
    buffer_load_dwordx4 v[28:31], v1, s[4:7], s65 offen offset:1024 sc1
    buffer_load_dwordx4 v[32:35], v1, s[4:7], s65 offen offset:2048 sc1
    buffer_load_dwordx4 v[36:39], v1, s[4:7], s65 offen offset:3072 sc1
    v_exp_f32 v56, v220 clamp
    v_exp_f32 v57, v221 clamp
    v_exp_f32 v58, v222 clamp
    v_exp_f32 v59, v223 clamp
    v_pk_fma_f32 v[220:221], v[220:221], v[84:85], v[84:85] op_sel:[0,0,1] op_sel_hi:[1,0,1]
    v_pk_fma_f32 v[222:223], v[222:223], v[84:85], v[84:85] op_sel:[0,0,1] op_sel_hi:[1,0,1]
    v_pk_add_f32 v[56:57], v[56:57], s[92:93] op_sel_hi:[1,0]
    v_pk_add_f32 v[58:59], v[58:59], s[92:93] op_sel_hi:[1,0]
    v_max_f32 v220, v220, v56
    v_max_f32 v221, v221, v57
    v_max_f32 v222, v222, v58
    v_max_f32 v223, v223, v59
    v_cvt_pk_bf16_f32 v204, v220, v221
    v_cvt_pk_bf16_f32 v205, v222, v223
    v_pk_fma_f32 v[224:225], v[234:235], v[88:89], v[224:225] op_sel_hi:[0,1,1] neg_lo:[1,0,0] neg_hi:[1,0,0]
    v_pk_fma_f32 v[226:227], v[234:235], v[90:91], v[226:227] op_sel_hi:[0,1,1] neg_lo:[1,0,0] neg_hi:[1,0,0]
    v_pk_mul_f32 v[224:225], v[224:225], v[234:235] op_sel:[0,1] op_sel_hi:[1,1]
    v_pk_mul_f32 v[226:227], v[226:227], v[234:235] op_sel:[0,1] op_sel_hi:[1,1]
    v_exp_f32 v56, v224 clamp
    v_exp_f32 v57, v225 clamp
    v_exp_f32 v58, v226 clamp
    v_exp_f32 v59, v227 clamp
    v_pk_fma_f32 v[224:225], v[224:225], v[84:85], v[84:85] op_sel:[0,0,1] op_sel_hi:[1,0,1]
    v_pk_fma_f32 v[226:227], v[226:227], v[84:85], v[84:85] op_sel:[0,0,1] op_sel_hi:[1,0,1]
    v_pk_add_f32 v[56:57], v[56:57], s[92:93] op_sel_hi:[1,0]
    v_pk_add_f32 v[58:59], v[58:59], s[92:93] op_sel_hi:[1,0]
    v_max_f32 v224, v224, v56
    v_max_f32 v225, v225, v57
    v_max_f32 v226, v226, v58
    v_max_f32 v227, v227, v59
    v_cvt_pk_bf16_f32 v206, v224, v225
    v_cvt_pk_bf16_f32 v207, v226, v227
L_kva66:
    s_waitcnt vmcnt(8)
    v_max3_u32 v52, v40, v41, v42
    v_max_u32 v52, v52, v43
    v_add_f32_dpp v44, v40, v40 row_ror:8 row_mask:0xf bank_mask:0xf
    v_add_f32_dpp v45, v41, v41 row_ror:8 row_mask:0xf bank_mask:0xf
    v_add_f32_dpp v46, v42, v42 row_ror:8 row_mask:0xf bank_mask:0xf
    v_add_f32_dpp v47, v43, v43 row_ror:8 row_mask:0xf bank_mask:0xf
    v_add_f32_dpp v44, v44, v44 row_ror:4 row_mask:0xf bank_mask:0xf
    v_add_f32_dpp v45, v45, v45 row_ror:4 row_mask:0xf bank_mask:0xf
    v_add_f32_dpp v46, v46, v46 row_ror:4 row_mask:0xf bank_mask:0xf
    v_add_f32_dpp v47, v47, v47 row_ror:4 row_mask:0xf bank_mask:0xf
    v_add_f32_dpp v44, v44, v44 row_ror:2 row_mask:0xf bank_mask:0xf
    v_add_f32_dpp v45, v45, v45 row_ror:2 row_mask:0xf bank_mask:0xf
    v_add_f32_dpp v46, v46, v46 row_ror:2 row_mask:0xf bank_mask:0xf
    v_add_f32_dpp v47, v47, v47 row_ror:2 row_mask:0xf bank_mask:0xf
    v_add_f32_dpp v44, v44, v44 row_ror:1 row_mask:0xf bank_mask:0xf
    v_add_f32_dpp v45, v45, v45 row_ror:1 row_mask:0xf bank_mask:0xf
    v_add_f32_dpp v46, v46, v46 row_ror:1 row_mask:0xf bank_mask:0xf
    v_add_f32_dpp v47, v47, v47 row_ror:1 row_mask:0xf bank_mask:0xf
    v_cvt_pk_bf16_f32 v62, v44, v45
    v_cvt_pk_bf16_f32 v63, v46, v47
    s_nop 1
    v_mfma_f32_16x16x16_bf16 v[236:239], v[62:63], v[200:201], 0
    v_mfma_f32_16x16x16_bf16 v[240:243], v[62:63], v[202:203], 0
    v_mfma_f32_16x16x16_bf16 v[244:247], v[62:63], v[204:205], 0
    v_mfma_f32_16x16x16_bf16 v[248:251], v[62:63], v[206:207], 0
    s_waitcnt vmcnt(7)
    v_max3_u32 v52, v52, v8, v9
    v_dot2_f32_bf16 v68, v8, s96, 0
    v_dot2_f32_bf16 v69, v8, s97, 0
    v_dot2_f32_bf16 v70, v9, s96, 0
    v_dot2_f32_bf16 v71, v9, s97, 0
    v_dot2_f32_bf16 v72, v10, s96, 0
    v_dot2_f32_bf16 v73, v10, s97, 0
    v_dot2_f32_bf16 v74, v11, s96, 0
    v_dot2_f32_bf16 v75, v11, s97, 0
    v_max3_u32 v52, v52, v10, v11
    s_waitcnt vmcnt(6)
    v_max3_u32 v52, v52, v12, v13
    v_dot2_f32_bf16 v68, v12, s96, v68
    v_dot2_f32_bf16 v69, v12, s97, v69
    v_dot2_f32_bf16 v70, v13, s96, v70
    v_dot2_f32_bf16 v71, v13, s97, v71
    v_dot2_f32_bf16 v72, v14, s96, v72
    v_dot2_f32_bf16 v73, v14, s97, v73
    v_dot2_f32_bf16 v74, v15, s96, v74
    v_dot2_f32_bf16 v75, v15, s97, v75
    v_max3_u32 v52, v52, v14, v15
    v_add_f32 v236, s92, v236
    v_add_f32 v240, s92, v240
    v_add_f32 v244, s92, v244
    v_add_f32 v248, s92, v248
    v_rcp_f32 v236, v236
    v_rcp_f32 v240, v240
    v_rcp_f32 v244, v244
    v_rcp_f32 v248, v248
    s_waitcnt vmcnt(5)
    v_max3_u32 v52, v52, v16, v17
    v_dot2_f32_bf16 v68, v16, s96, v68
    v_dot2_f32_bf16 v69, v16, s97, v69
    v_dot2_f32_bf16 v70, v17, s96, v70
    v_dot2_f32_bf16 v71, v17, s97, v71
    v_dot2_f32_bf16 v72, v18, s96, v72
    v_dot2_f32_bf16 v73, v18, s97, v73
    v_dot2_f32_bf16 v74, v19, s96, v74
    v_dot2_f32_bf16 v75, v19, s97, v75
    v_max3_u32 v52, v52, v18, v19
    s_waitcnt vmcnt(4)
    v_max3_u32 v52, v52, v20, v21
    v_dot2_f32_bf16 v68, v20, s96, v68
    v_dot2_f32_bf16 v69, v20, s97, v69
    v_dot2_f32_bf16 v70, v21, s96, v70
    v_dot2_f32_bf16 v71, v21, s97, v71
    v_dot2_f32_bf16 v72, v22, s96, v72
    v_dot2_f32_bf16 v73, v22, s97, v73
    v_dot2_f32_bf16 v74, v23, s96, v74
    v_dot2_f32_bf16 v75, v23, s97, v75
    v_max3_u32 v52, v52, v22, v23
    s_waitcnt vmcnt(3)
    v_max3_u32 v52, v52, v24, v25
    v_dot2_f32_bf16 v68, v24, s96, v68
    v_dot2_f32_bf16 v69, v24, s97, v69
    v_dot2_f32_bf16 v70, v25, s96, v70
    v_dot2_f32_bf16 v71, v25, s97, v71
    v_dot2_f32_bf16 v72, v26, s96, v72
    v_dot2_f32_bf16 v73, v26, s97, v73
    v_dot2_f32_bf16 v74, v27, s96, v74
    v_dot2_f32_bf16 v75, v27, s97, v75
    v_max3_u32 v52, v52, v26, v27
    s_waitcnt vmcnt(2)
    v_max3_u32 v52, v52, v28, v29
    v_dot2_f32_bf16 v68, v28, s96, v68
    v_dot2_f32_bf16 v69, v28, s97, v69
    v_dot2_f32_bf16 v70, v29, s96, v70
    v_dot2_f32_bf16 v71, v29, s97, v71
    v_dot2_f32_bf16 v72, v30, s96, v72
    v_dot2_f32_bf16 v73, v30, s97, v73
    v_dot2_f32_bf16 v74, v31, s96, v74
    v_dot2_f32_bf16 v75, v31, s97, v75
    v_max3_u32 v52, v52, v30, v31
    s_waitcnt vmcnt(1)
    v_max3_u32 v52, v52, v32, v33
    v_dot2_f32_bf16 v68, v32, s96, v68
    v_dot2_f32_bf16 v69, v32, s97, v69
    v_dot2_f32_bf16 v70, v33, s96, v70
    v_dot2_f32_bf16 v71, v33, s97, v71
    v_dot2_f32_bf16 v72, v34, s96, v72
    v_dot2_f32_bf16 v73, v34, s97, v73
    v_dot2_f32_bf16 v74, v35, s96, v74
    v_dot2_f32_bf16 v75, v35, s97, v75
    v_max3_u32 v52, v52, v34, v35
    s_waitcnt vmcnt(0)
    v_max3_u32 v52, v52, v36, v37
    v_dot2_f32_bf16 v68, v36, s96, v68
    v_dot2_f32_bf16 v69, v36, s97, v69
    v_dot2_f32_bf16 v70, v37, s96, v70
    v_dot2_f32_bf16 v71, v37, s97, v71
    v_dot2_f32_bf16 v72, v38, s96, v72
    v_dot2_f32_bf16 v73, v38, s97, v73
    v_dot2_f32_bf16 v74, v39, s96, v74
    v_dot2_f32_bf16 v75, v39, s97, v75
    v_max3_u32 v52, v52, v38, v39
    v_cmp_eq_u32 vcc, -1, v52
    s_cbranch_vccnz L_ool67
L_back68:
    v_cmp_ne_u32 vcc, s47, v80
    s_cbranch_vccnz L_ool69
L_back70:
    v_permlane32_swap_b32 v68, v72
    v_permlane32_swap_b32 v69, v73
    v_permlane32_swap_b32 v70, v74
    v_permlane32_swap_b32 v71, v75
    v_pk_add_f32 v[68:69], v[68:69], v[72:73]
    v_pk_add_f32 v[70:71], v[70:71], v[74:75]
    v_cvt_pk_bf16_f32 v60, v68, v69
    v_cvt_pk_bf16_f32 v61, v70, v71
    s_nop 1
    v_mfma_f32_16x16x16_bf16 v[8:11], v[60:61], v[200:201], 0
    v_mfma_f32_16x16x16_bf16 v[12:15], v[60:61], v[202:203], 0
    v_mfma_f32_16x16x16_bf16 v[16:19], v[60:61], v[204:205], 0
    v_mfma_f32_16x16x16_bf16 v[20:23], v[60:61], v[206:207], 0
    s_nop 4
    v_pk_mul_f32 v[8:9], v[8:9], v[236:237] op_sel_hi:[1,0]
    v_pk_mul_f32 v[10:11], v[10:11], v[236:237] op_sel_hi:[1,0]
    v_pk_mul_f32 v[12:13], v[12:13], v[240:241] op_sel_hi:[1,0]
    v_pk_mul_f32 v[14:15], v[14:15], v[240:241] op_sel_hi:[1,0]
    v_cvt_pk_bf16_f32 v40, v8, v9
    v_cvt_pk_bf16_f32 v41, v10, v11
    v_cvt_pk_bf16_f32 v42, v12, v13
    v_cvt_pk_bf16_f32 v43, v14, v15
    buffer_store_dwordx4 v[40:43], v1, s[36:39], s67 offen
    v_pk_mul_f32 v[16:17], v[16:17], v[244:245] op_sel_hi:[1,0]
    v_pk_mul_f32 v[18:19], v[18:19], v[244:245] op_sel_hi:[1,0]
    v_pk_mul_f32 v[20:21], v[20:21], v[248:249] op_sel_hi:[1,0]
    v_pk_mul_f32 v[22:23], v[22:23], v[248:249] op_sel_hi:[1,0]
    v_cvt_pk_bf16_f32 v44, v16, v17
    v_cvt_pk_bf16_f32 v45, v18, v19
    v_cvt_pk_bf16_f32 v46, v20, v21
    v_cvt_pk_bf16_f32 v47, v22, v23
    buffer_store_dwordx4 v[44:47], v1, s[36:39], s68 offen
    v_and_b32 v40, 7, v0
    v_lshlrev_b32 v40, 2, v40
    s_lshl_b32 s71, s50, 6
    s_and_b32 s71, s71, 0xffffff80
    s_lshl_b32 s58, s46, 5
    s_add_u32 s71, s71, s58
    s_add_u32 s71, s71, 20480
    s_lshl_b32 s64, s50, 15
    s_add_u32 s64, s64, 0
    v_add_u32 v41, s64, v1
    s_lshl_b32 s66, s46, 13
    s_add_u32 m0, s66, 131072
    v_add_u32 v197, 131072, v1
    s_lshl_b32 s72, s50, 6
    s_add_u32 s72, s72, 36864
    s_lshl_b32 s60, s51, 2
    s_add_u32 s68, s72, s60
    v_and_b32 v45, 3, v0
    v_lshlrev_b32 v45, 2, v45
    s_waitcnt vmcnt(0)
    s_cmp_lg_u32 s49, 0
    s_cbranch_scc1 L_ool71
L_back72:
    s_mov_b64 exec, 1
    buffer_store_dword v98, v2, s[4:7], s69 offen
    s_mov_b64 exec, -1
    s_barrier
    s_cmp_eq_u32 s49, 0
    s_cselect_b32 s57, 400000, 0
L_pl73:
    buffer_load_dword v42, v40, s[4:7], s71 offen sc1
    s_sub_u32 s57, s57, 1
    s_waitcnt vmcnt(0)
    v_cmp_ne_u32 vcc, s47, v42
    s_cbranch_scc1 L_ps75
    s_cbranch_vccnz L_pl73
L_pe76:
    buffer_load_dwordx4 v41, s[36:39], s66 offen offset:0 sc1 lds
    buffer_load_dwordx4 v41, s[36:39], s66 offen offset:1024 sc1 lds
    buffer_load_dwordx4 v41, s[36:39], s66 offen offset:2048 sc1 lds
    buffer_load_dwordx4 v41, s[36:39], s66 offen offset:3072 sc1 lds
    s_add_u32 m0, m0, 4096
    s_add_u32 s66, s66, 4096
    buffer_load_dwordx4 v41, s[36:39], s66 offen offset:0 sc1 lds
    buffer_load_dwordx4 v41, s[36:39], s66 offen offset:1024 sc1 lds
    buffer_load_dwordx4 v41, s[36:39], s66 offen offset:2048 sc1 lds
    buffer_load_dwordx4 v41, s[36:39], s66 offen offset:3072 sc1 lds
    s_waitcnt vmcnt(6)
    s_barrier
    ds_read_b128 v[8:11], v197 offset:0
    ds_read_b128 v[12:15], v197 offset:1024
    ds_read_b128 v[16:19], v197 offset:8192
    ds_read_b128 v[20:23], v197 offset:9216
    ds_read_b128 v[24:27], v197 offset:16384
    ds_read_b128 v[28:31], v197 offset:17408
    s_waitcnt lgkmcnt(4)
    v_swap_b32 v10, v12
    v_swap_b32 v11, v13
    s_nop 1
    v_mfma_f32_16x16x32_bf16 v[112:115], v[128:131], v[8:11], v[112:115]
    s_waitcnt lgkmcnt(2)
    v_swap_b32 v18, v20
    v_mfma_f32_16x16x32_bf16 v[116:119], a[192:195], v[8:11], v[116:119]
    v_swap_b32 v19, v21
    v_mfma_f32_16x16x32_bf16 v[120:123], v[128:131], v[12:15], v[120:123]
    ds_read_b128 v[32:35], v197 offset:24576
    v_mfma_f32_16x16x32_bf16 v[124:127], a[192:195], v[12:15], v[124:127]
    ds_read_b128 v[36:39], v197 offset:25600
    v_mfma_f32_16x16x32_bf16 v[112:115], v[144:147], v[16:19], v[112:115]
    s_waitcnt lgkmcnt(2)
    v_swap_b32 v26, v28
    v_mfma_f32_16x16x32_bf16 v[116:119], a[208:211], v[16:19], v[116:119]
    v_swap_b32 v27, v29
    v_mfma_f32_16x16x32_bf16 v[120:123], v[144:147], v[20:23], v[120:123]
    s_waitcnt vmcnt(0)
    s_barrier
    s_cmp_lg_u32 s49, 0
    s_cbranch_scc1 L_ool78
L_back79:
    s_mov_b64 exec, 1
    buffer_store_dword v98, v87, s[4:7], s68 offen
    s_mov_b64 exec, -1
    ds_read_b128 v[8:11], v197 offset:2048
    v_mfma_f32_16x16x32_bf16 v[124:127], a[208:211], v[20:23], v[124:127]
    ds_read_b128 v[12:15], v197 offset:3072
    v_mfma_f32_16x16x32_bf16 v[112:115], v[160:163], v[24:27], v[112:115]
    s_waitcnt lgkmcnt(2)
    v_swap_b32 v34, v36
    v_mfma_f32_16x16x32_bf16 v[116:119], a[224:227], v[24:27], v[116:119]
    v_swap_b32 v35, v37
    v_mfma_f32_16x16x32_bf16 v[120:123], v[160:163], v[28:31], v[120:123]
    ds_read_b128 v[16:19], v197 offset:10240
    v_mfma_f32_16x16x32_bf16 v[124:127], a[224:227], v[28:31], v[124:127]
    ds_read_b128 v[20:23], v197 offset:11264
    v_mfma_f32_16x16x32_bf16 v[112:115], v[176:179], v[32:35], v[112:115]
    s_waitcnt lgkmcnt(2)
    v_swap_b32 v10, v12
    v_mfma_f32_16x16x32_bf16 v[116:119], a[240:243], v[32:35], v[116:119]
    v_swap_b32 v11, v13
    v_mfma_f32_16x16x32_bf16 v[120:123], v[176:179], v[36:39], v[120:123]
    ds_read_b128 v[24:27], v197 offset:18432
    v_mfma_f32_16x16x32_bf16 v[124:127], a[240:243], v[36:39], v[124:127]
    ds_read_b128 v[28:31], v197 offset:19456
    v_mfma_f32_16x16x32_bf16 v[112:115], v[132:135], v[8:11], v[112:115]
    s_waitcnt lgkmcnt(2)
    v_swap_b32 v18, v20
    v_mfma_f32_16x16x32_bf16 v[116:119], a[196:199], v[8:11], v[116:119]
    v_swap_b32 v19, v21
    v_mfma_f32_16x16x32_bf16 v[120:123], v[132:135], v[12:15], v[120:123]
    ds_read_b128 v[32:35], v197 offset:26624
    v_mfma_f32_16x16x32_bf16 v[124:127], a[196:199], v[12:15], v[124:127]
    ds_read_b128 v[36:39], v197 offset:27648
    v_mfma_f32_16x16x32_bf16 v[112:115], v[148:151], v[16:19], v[112:115]
    s_waitcnt lgkmcnt(2)
    v_swap_b32 v26, v28
    v_mfma_f32_16x16x32_bf16 v[116:119], a[212:215], v[16:19], v[116:119]
    v_swap_b32 v27, v29
    v_mfma_f32_16x16x32_bf16 v[120:123], v[148:151], v[20:23], v[120:123]
    ds_read_b128 v[8:11], v197 offset:4096
    v_mfma_f32_16x16x32_bf16 v[124:127], a[212:215], v[20:23], v[124:127]
    ds_read_b128 v[12:15], v197 offset:5120
    v_mfma_f32_16x16x32_bf16 v[112:115], v[164:167], v[24:27], v[112:115]
    s_waitcnt lgkmcnt(2)
    v_swap_b32 v34, v36
    v_mfma_f32_16x16x32_bf16 v[116:119], a[228:231], v[24:27], v[116:119]
    v_swap_b32 v35, v37
    v_mfma_f32_16x16x32_bf16 v[120:123], v[164:167], v[28:31], v[120:123]
    ds_read_b128 v[16:19], v197 offset:12288
    v_mfma_f32_16x16x32_bf16 v[124:127], a[228:231], v[28:31], v[124:127]
    ds_read_b128 v[20:23], v197 offset:13312
    v_mfma_f32_16x16x32_bf16 v[112:115], v[180:183], v[32:35], v[112:115]
    s_waitcnt lgkmcnt(2)
    v_swap_b32 v10, v12
    v_mfma_f32_16x16x32_bf16 v[116:119], a[244:247], v[32:35], v[116:119]
    v_swap_b32 v11, v13
    v_mfma_f32_16x16x32_bf16 v[120:123], v[180:183], v[36:39], v[120:123]
    ds_read_b128 v[24:27], v197 offset:20480
    v_mfma_f32_16x16x32_bf16 v[124:127], a[244:247], v[36:39], v[124:127]
    ds_read_b128 v[28:31], v197 offset:21504
    v_mfma_f32_16x16x32_bf16 v[112:115], v[136:139], v[8:11], v[112:115]
    s_waitcnt lgkmcnt(2)
    v_swap_b32 v18, v20
    v_mfma_f32_16x16x32_bf16 v[116:119], a[200:203], v[8:11], v[116:119]
    v_swap_b32 v19, v21
    v_mfma_f32_16x16x32_bf16 v[120:123], v[136:139], v[12:15], v[120:123]
    ds_read_b128 v[32:35], v197 offset:28672
    v_mfma_f32_16x16x32_bf16 v[124:127], a[200:203], v[12:15], v[124:127]
    ds_read_b128 v[36:39], v197 offset:29696
    v_mfma_f32_16x16x32_bf16 v[112:115], v[152:155], v[16:19], v[112:115]
    s_waitcnt lgkmcnt(2)
    v_swap_b32 v26, v28
    v_mfma_f32_16x16x32_bf16 v[116:119], a[216:219], v[16:19], v[116:119]
    v_swap_b32 v27, v29
    v_mfma_f32_16x16x32_bf16 v[120:123], v[152:155], v[20:23], v[120:123]
    ds_read_b128 v[8:11], v197 offset:6144
    v_mfma_f32_16x16x32_bf16 v[124:127], a[216:219], v[20:23], v[124:127]
    ds_read_b128 v[12:15], v197 offset:7168
    v_mfma_f32_16x16x32_bf16 v[112:115], v[168:171], v[24:27], v[112:115]
    s_waitcnt lgkmcnt(2)
    v_swap_b32 v34, v36
    v_mfma_f32_16x16x32_bf16 v[116:119], a[232:235], v[24:27], v[116:119]
    v_swap_b32 v35, v37
    v_mfma_f32_16x16x32_bf16 v[120:123], v[168:171], v[28:31], v[120:123]
    ds_read_b128 v[16:19], v197 offset:14336
    v_mfma_f32_16x16x32_bf16 v[124:127], a[232:235], v[28:31], v[124:127]
    ds_read_b128 v[20:23], v197 offset:15360
    v_mfma_f32_16x16x32_bf16 v[112:115], v[184:187], v[32:35], v[112:115]
    s_waitcnt lgkmcnt(2)
    v_swap_b32 v10, v12
    v_mfma_f32_16x16x32_bf16 v[116:119], a[248:251], v[32:35], v[116:119]
    v_swap_b32 v11, v13
    v_mfma_f32_16x16x32_bf16 v[120:123], v[184:187], v[36:39], v[120:123]
    ds_read_b128 v[24:27], v197 offset:22528
    v_mfma_f32_16x16x32_bf16 v[124:127], a[248:251], v[36:39], v[124:127]
    ds_read_b128 v[28:31], v197 offset:23552
    buffer_load_dword v42, v45, s[4:7], s72 offen sc1
    v_mfma_f32_16x16x32_bf16 v[112:115], v[140:143], v[8:11], v[112:115]
    s_waitcnt lgkmcnt(2)
    v_swap_b32 v18, v20
    v_mfma_f32_16x16x32_bf16 v[116:119], a[204:207], v[8:11], v[116:119]
    v_swap_b32 v19, v21
    v_mfma_f32_16x16x32_bf16 v[120:123], v[140:143], v[12:15], v[120:123]
    ds_read_b128 v[32:35], v197 offset:30720
    v_mfma_f32_16x16x32_bf16 v[124:127], a[204:207], v[12:15], v[124:127]
    ds_read_b128 v[36:39], v197 offset:31744
    v_mfma_f32_16x16x32_bf16 v[112:115], v[156:159], v[16:19], v[112:115]
    s_waitcnt lgkmcnt(2)
    v_swap_b32 v26, v28
    v_mfma_f32_16x16x32_bf16 v[116:119], a[220:223], v[16:19], v[116:119]
    v_swap_b32 v27, v29
    v_mfma_f32_16x16x32_bf16 v[120:123], v[156:159], v[20:23], v[120:123]
    v_mfma_f32_16x16x32_bf16 v[124:127], a[220:223], v[20:23], v[124:127]
    v_mfma_f32_16x16x32_bf16 v[112:115], v[172:175], v[24:27], v[112:115]
    s_waitcnt lgkmcnt(0)
    v_swap_b32 v34, v36
    v_mfma_f32_16x16x32_bf16 v[116:119], a[236:239], v[24:27], v[116:119]
    v_swap_b32 v35, v37
    v_mfma_f32_16x16x32_bf16 v[120:123], v[172:175], v[28:31], v[120:123]
    v_mfma_f32_16x16x32_bf16 v[124:127], a[236:239], v[28:31], v[124:127]
    v_mfma_f32_16x16x32_bf16 v[112:115], v[188:191], v[32:35], v[112:115]
    v_mfma_f32_16x16x32_bf16 v[116:119], a[252:255], v[32:35], v[116:119]
    v_mfma_f32_16x16x32_bf16 v[120:123], v[188:191], v[36:39], v[120:123]
    v_mfma_f32_16x16x32_bf16 v[124:127], a[252:255], v[36:39], v[124:127]
    v_add_u32 v4, 0x4000, v3
    s_waitcnt vmcnt(0)
    v_cmp_ne_u32 vcc, s47, v42
    s_cbranch_vccnz L_ool80
L_back81:
    s_nop 0
    v_cvt_pk_bf16_f32 v8, v112, v113
    v_cvt_pk_bf16_f32 v9, v114, v115
    v_cvt_pk_bf16_f32 v10, v116, v117
    v_cvt_pk_bf16_f32 v11, v118, v119
    buffer_store_dwordx4 v[8:11], v3, s[36:39], 0 offen
    v_cvt_pk_bf16_f32 v12, v120, v121
    v_cvt_pk_bf16_f32 v13, v122, v123
    v_cvt_pk_bf16_f32 v14, v124, v125
    v_cvt_pk_bf16_f32 v15, v126, v127
    buffer_store_dwordx4 v[12:15], v4, s[36:39], 0 offen
    s_cmp_lg_u32 s2, 0
    s_cbranch_scc1 L_n82
    buffer_store_dword v99, v87, s[4:7], 0 offen sc1
L_n82:
L_end:
    s_endpgm
L_last:
L_ool3:
    s_waitcnt vmcnt(0)
    buffer_wbl2 sc1
    s_waitcnt vmcnt(0)
    s_add_u32 s61, s72, 65536
    buffer_store_dword v99, v2, s[4:7], s61 offen sc1
    s_waitcnt vmcnt(0)
    s_nop 3
    s_branch L_back4
L_ps7:
    s_cmp_lg_u32 s49, 0
    s_cbranch_scc1 L_pk84
    s_mov_b32 s49, 1
    buffer_wbl2 sc1
    s_waitcnt vmcnt(0)
    s_add_u32 s61, s72, 65536
    buffer_store_dword v99, v2, s[4:7], s61 offen sc1
    s_waitcnt vmcnt(0)
L_pk84:
    s_mov_b32 s57, 0
    s_add_u32 s61, s71, 65536
L_pt83:
    buffer_load_dwordx2 v[14:15], v71, s[4:7], s71 offen sc1
    buffer_load_dwordx2 v[16:17], v71, s[4:7], s61 offen sc1
    s_add_u32 s57, s57, 1
    s_waitcnt vmcnt(0)
    v_xor_b32 v14, s47, v14
    v_xor_b32 v16, s48, v16
    v_min_u32 v14, v14, v16
    v_xor_b32 v15, s47, v15
    v_xor_b32 v17, s48, v17
    v_min_u32 v15, v15, v17
    v_or_b32 v14, v14, v15
    v_cmp_ne_u32 vcc, 0, v14
    s_cmp_gt_u32 s57, 400000
    s_cbranch_scc1 L_pd6
    s_cbranch_vccnz L_pt83
L_pd6:
    buffer_inv sc1
    s_waitcnt vmcnt(0)
    s_nop 3
    s_branch L_pe8
L_ool12:
    s_waitcnt vmcnt(0)
    s_add_u32 s61, s69, 65536
    buffer_store_dword v99, v87, s[4:7], s61 offen sc1
    s_waitcnt vmcnt(0)
    s_nop 3
    s_branch L_back13
L_ool14:
    s_waitcnt vmcnt(0)
    buffer_wbl2 sc1
    s_waitcnt vmcnt(0)
    s_nop 3
    s_branch L_back15
L_ool16:
    s_mov_b32 s57, 0
L_rt85:
    buffer_load_dword v65, v64, s[4:7], s42 offen sc1
    s_add_u32 s57, s57, 1
    s_waitcnt vmcnt(0)
    v_cmp_ne_u32 vcc, s48, v65
    s_cmp_gt_u32 s57, 400000
    s_cbranch_scc1 L_rd86
    s_cbranch_vccnz L_rt85
L_rd86:
    s_nop 3
    s_branch L_back17
L_ool18:
    s_mov_b32 s57, 0
L_rt88:
    s_cmp_eq_u32 s49, 0
    s_cbranch_scc1 L_ri90
    buffer_inv sc1
    s_waitcnt vmcnt(0)
L_ri90:
    buffer_load_dwordx4 v[8:11], v1, s[4:7], s69 offen offset:0 sc1
    buffer_load_dwordx4 v[12:15], v1, s[4:7], s69 offen offset:1024 sc1
    s_add_u32 s57, s57, 1
    s_waitcnt vmcnt(0)
    v_bitop3_b32 v16, v8, v9, s70 bitop3:0x96
    v_bitop3_b32 v17, v10, v11, s70 bitop3:0x96
    v_bitop3_b32 v18, v12, v13, s70 bitop3:0x96
    v_bitop3_b32 v19, v14, v15, s70 bitop3:0x96
    v_or3_b32 v16, v16, v17, v18
    v_or_b32 v16, v16, v19
    v_cmp_ne_u32 vcc, 0, v16
    s_cmp_gt_u32 s57, 400000
    s_cbranch_scc1 L_rd89
    s_cbranch_vccnz L_rt88
L_rd89:
    s_nop 3
    s_branch L_back19
L_ool20:
    s_cmp_eq_u32 s49, 0
    s_cselect_b32 s57, 400000, 0
L_pl91:
    buffer_load_dword v48, v46, s[4:7], s68 offen sc1
    s_sub_u32 s57, s57, 1
    s_waitcnt vmcnt(0)
    v_cmp_ne_u32 vcc, s47, v48
    s_cbranch_scc1 L_ps93
    s_cbranch_vccnz L_pl91
L_pe94:
    s_nop 3
    s_branch L_back21
L_ool22:
    s_mov_b32 s57, 0
L_rt96:
    buffer_load_dwordx4 v[24:27], v47, s[4:7], s64 offen sc1
    buffer_load_dwordx4 v[28:31], v47, s[4:7], s64 offen offset:2048 sc1
    s_add_u32 s57, s57, 1
    s_waitcnt vmcnt(0)
    v_max3_u32 v32, v24, v25, v26
    v_max3_u32 v33, v27, v28, v29
    v_max3_u32 v32, v32, v30, v31
    v_max_u32 v32, v32, v33
    v_cmp_eq_u32 vcc, -1, v32
    s_cmp_gt_u32 s57, 400000
    s_cbranch_scc1 L_rd97
    s_cbranch_vccnz L_rt96
L_rd97:
    s_nop 3
    s_branch L_back23
L_ool24:
    s_waitcnt vmcnt(0)
    buffer_wbl2 sc1
    s_waitcnt vmcnt(0)
    s_nop 3
    s_branch L_back25
L_ool26:
    s_waitcnt vmcnt(0)
    buffer_wbl2 sc1
    s_waitcnt vmcnt(0)
    s_add_u32 s61, s68, 65536
    buffer_store_dword v99, v2, s[4:7], s61 offen sc1
    s_waitcnt vmcnt(0)
    s_nop 3
    s_branch L_back27
L_ps30:
    s_cmp_lg_u32 s49, 0
    s_cbranch_scc1 L_pk100
    s_branch L_pe31
L_pk100:
    s_mov_b32 s57, 0
    s_add_u32 s61, s71, 65536
L_pt99:
    buffer_load_dword v42, v40, s[4:7], s71 offen sc1
    buffer_load_dword v44, v40, s[4:7], s61 offen sc1
    s_add_u32 s57, s57, 1
    s_waitcnt vmcnt(0)
    v_xor_b32 v42, s47, v42
    v_xor_b32 v44, s48, v44
    v_min_u32 v42, v42, v44
    v_cmp_ne_u32 vcc, 0, v42
    s_cmp_gt_u32 s57, 400000
    s_cbranch_scc1 L_pd29
    s_cbranch_vccnz L_pt99
L_pd29:
    buffer_inv sc1
    s_waitcnt vmcnt(0)
    s_nop 3
    s_branch L_pe31
L_ool33:
    s_mov_b32 s57, 0
L_rt101:
    s_cmp_eq_u32 s49, 0
    s_cbranch_scc1 L_ri103
    buffer_inv sc1
    s_waitcnt vmcnt(0)
L_ri103:
    buffer_load_dwordx4 v[48:51], v1, s[4:7], s78 offen offset:0 sc1
    buffer_load_dwordx4 v[52:55], v1, s[4:7], s78 offen offset:1024 sc1
    s_add_u32 s57, s57, 1
    s_waitcnt vmcnt(0)
    v_bitop3_b32 v56, v48, v49, s70 bitop3:0x96
    v_bitop3_b32 v57, v50, v51, s70 bitop3:0x96
    v_bitop3_b32 v58, v52, v53, s70 bitop3:0x96
    v_bitop3_b32 v59, v54, v55, s70 bitop3:0x96
    v_or3_b32 v56, v56, v57, v58
    v_or_b32 v56, v56, v59
    v_cmp_ne_u32 vcc, 0, v56
    s_cmp_gt_u32 s57, 400000
    s_cbranch_scc1 L_rd102
    s_cbranch_vccnz L_rt101
L_rd102:
    s_nop 3
    s_branch L_back34
L_ool35:
    s_waitcnt vmcnt(0)
    s_add_u32 s61, s72, 65536
    buffer_store_dword v99, v87, s[4:7], s61 offen sc1
    s_waitcnt vmcnt(0)
    s_nop 3
    s_branch L_back36
L_ool38:
    s_mov_b32 s57, 0
L_rt104:
    buffer_load_dwordx4 v[40:43], v208, s[4:7], s42 offen sc1
    buffer_load_dwordx4 v[8:11], v1, s[4:7], s64 offen offset:0 sc1
    buffer_load_dwordx4 v[12:15], v1, s[4:7], s64 offen offset:1024 sc1
    buffer_load_dwordx4 v[16:19], v1, s[4:7], s64 offen offset:2048 sc1
    buffer_load_dwordx4 v[20:23], v1, s[4:7], s64 offen offset:3072 sc1
    buffer_load_dwordx4 v[24:27], v1, s[4:7], s65 offen offset:0 sc1
    buffer_load_dwordx4 v[28:31], v1, s[4:7], s65 offen offset:1024 sc1
    buffer_load_dwordx4 v[32:35], v1, s[4:7], s65 offen offset:2048 sc1
    buffer_load_dwordx4 v[36:39], v1, s[4:7], s65 offen offset:3072 sc1
    s_add_u32 s57, s57, 1
    s_waitcnt vmcnt(0)
    v_max3_u32 v52, v8, v9, v10
    v_max3_u32 v52, v52, v11, v12
    v_max3_u32 v52, v52, v13, v14
    v_max3_u32 v52, v52, v15, v16
    v_max3_u32 v52, v52, v17, v18
    v_max3_u32 v52, v52, v19, v20
    v_max3_u32 v52, v52, v21, v22
    v_max3_u32 v52, v52, v23, v24
    v_max3_u32 v52, v52, v25, v26
    v_max3_u32 v52, v52, v27, v28
    v_max3_u32 v52, v52, v29, v30
    v_max3_u32 v52, v52, v31, v32
    v_max3_u32 v52, v52, v33, v34
    v_max3_u32 v52, v52, v35, v36
    v_max3_u32 v52, v52, v37, v38
    v_max3_u32 v52, v52, v39, v40
    v_max3_u32 v52, v52, v41, v42
    v_max_u32 v52, v52, v43
    v_cmp_eq_u32 vcc, -1, v52
    s_cmp_gt_u32 s57, 400000
    s_cbranch_scc1 L_rd105
    s_cbranch_vccnz L_rt104
    s_branch L_kva37
L_rd105:
    s_nop 3
    s_branch L_back39
L_ool40:
    s_cmp_eq_u32 s49, 0
    s_cselect_b32 s57, 400000, 0
L_pl106:
    buffer_load_dword v80, v210, s[4:7], s71 offen sc1
    s_sub_u32 s57, s57, 1
    s_waitcnt vmcnt(0)
    v_cmp_ne_u32 vcc, s47, v80
    s_cbranch_scc1 L_ps108
    s_cbranch_vccnz L_pl106
L_pe109:
    s_nop 3
    s_branch L_back41
L_ool42:
    s_waitcnt vmcnt(0)
    buffer_wbl2 sc1
    s_waitcnt vmcnt(0)
    s_add_u32 s61, s69, 65536
    buffer_store_dword v99, v2, s[4:7], s61 offen sc1
    s_waitcnt vmcnt(0)
    s_nop 3
    s_branch L_back43
L_ps46:
    s_cmp_lg_u32 s49, 0
    s_cbranch_scc1 L_pk112
    s_branch L_pe47
L_pk112:
    s_mov_b32 s57, 0
    s_add_u32 s61, s71, 65536
L_pt111:
    buffer_load_dword v42, v40, s[4:7], s71 offen sc1
    buffer_load_dword v44, v40, s[4:7], s61 offen sc1
    s_add_u32 s57, s57, 1
    s_waitcnt vmcnt(0)
    v_xor_b32 v42, s47, v42
    v_xor_b32 v44, s48, v44
    v_min_u32 v42, v42, v44
    v_cmp_ne_u32 vcc, 0, v42
    s_cmp_gt_u32 s57, 400000
    s_cbranch_scc1 L_pd45
    s_cbranch_vccnz L_pt111
L_pd45:
    buffer_inv sc1
    s_waitcnt vmcnt(0)
    s_nop 3
    s_branch L_pe47
L_ool49:
    s_waitcnt vmcnt(0)
    buffer_wbl2 sc1
    s_waitcnt vmcnt(0)
    s_nop 3
    s_branch L_back50
L_ool51:
    s_mov_b32 s57, 0
L_rt113:
    s_cmp_eq_u32 s49, 0
    s_cbranch_scc1 L_ri115
    buffer_inv sc1
    s_waitcnt vmcnt(0)
L_ri115:
    buffer_load_dwordx4 v[8:11], v1, s[4:7], s69 offen offset:0 sc1
    buffer_load_dwordx4 v[12:15], v1, s[4:7], s69 offen offset:1024 sc1
    s_add_u32 s57, s57, 1
    s_waitcnt vmcnt(0)
    v_bitop3_b32 v16, v8, v9, s70 bitop3:0x96
    v_bitop3_b32 v17, v10, v11, s70 bitop3:0x96
    v_bitop3_b32 v18, v12, v13, s70 bitop3:0x96
    v_bitop3_b32 v19, v14, v15, s70 bitop3:0x96
    v_or3_b32 v16, v16, v17, v18
    v_or_b32 v16, v16, v19
    v_cmp_ne_u32 vcc, 0, v16
    s_cmp_gt_u32 s57, 400000
    s_cbranch_scc1 L_rd114
    s_cbranch_vccnz L_rt113
L_rd114:
    s_nop 3
    s_branch L_back52
L_ool53:
    s_waitcnt vmcnt(0)
    buffer_wbl2 sc1
    s_waitcnt vmcnt(0)
    s_nop 3
    s_branch L_back54
L_ool55:
    s_waitcnt vmcnt(0)
    buffer_wbl2 sc1
    s_waitcnt vmcnt(0)
    s_add_u32 s61, s68, 65536
    buffer_store_dword v99, v2, s[4:7], s61 offen sc1
    s_waitcnt vmcnt(0)
    s_nop 3
    s_branch L_back56
L_ps59:
    s_cmp_lg_u32 s49, 0
    s_cbranch_scc1 L_pk117
    s_branch L_pe60
L_pk117:
    s_mov_b32 s57, 0
    s_add_u32 s61, s71, 65536
L_pt116:
    buffer_load_dword v42, v40, s[4:7], s71 offen sc1
    buffer_load_dword v44, v40, s[4:7], s61 offen sc1
    s_add_u32 s57, s57, 1
    s_waitcnt vmcnt(0)
    v_xor_b32 v42, s47, v42
    v_xor_b32 v44, s48, v44
    v_min_u32 v42, v42, v44
    v_cmp_ne_u32 vcc, 0, v42
    s_cmp_gt_u32 s57, 400000
    s_cbranch_scc1 L_pd58
    s_cbranch_vccnz L_pt116
L_pd58:
    buffer_inv sc1
    s_waitcnt vmcnt(0)
    s_nop 3
    s_branch L_pe60
L_ool62:
    s_mov_b32 s57, 0
L_rt118:
    s_cmp_eq_u32 s49, 0
    s_cbranch_scc1 L_ri120
    buffer_inv sc1
    s_waitcnt vmcnt(0)
L_ri120:
    buffer_load_dwordx4 v[48:51], v1, s[4:7], s78 offen offset:0 sc1
    buffer_load_dwordx4 v[52:55], v1, s[4:7], s78 offen offset:1024 sc1
    s_add_u32 s57, s57, 1
    s_waitcnt vmcnt(0)
    v_bitop3_b32 v56, v48, v49, s70 bitop3:0x96
    v_bitop3_b32 v57, v50, v51, s70 bitop3:0x96
    v_bitop3_b32 v58, v52, v53, s70 bitop3:0x96
    v_bitop3_b32 v59, v54, v55, s70 bitop3:0x96
    v_or3_b32 v56, v56, v57, v58
    v_or_b32 v56, v56, v59
    v_cmp_ne_u32 vcc, 0, v56
    s_cmp_gt_u32 s57, 400000
    s_cbranch_scc1 L_rd119
    s_cbranch_vccnz L_rt118
L_rd119:
    s_nop 3
    s_branch L_back63
L_ool64:
    s_waitcnt vmcnt(0)
    s_add_u32 s61, s72, 65536
    buffer_store_dword v99, v87, s[4:7], s61 offen sc1
    s_waitcnt vmcnt(0)
    s_nop 3
    s_branch L_back65
L_ool67:
    s_mov_b32 s57, 0
L_rt121:
    buffer_load_dwordx4 v[40:43], v208, s[4:7], s42 offen sc1
    buffer_load_dwordx4 v[8:11], v1, s[4:7], s64 offen offset:0 sc1
    buffer_load_dwordx4 v[12:15], v1, s[4:7], s64 offen offset:1024 sc1
    buffer_load_dwordx4 v[16:19], v1, s[4:7], s64 offen offset:2048 sc1
    buffer_load_dwordx4 v[20:23], v1, s[4:7], s64 offen offset:3072 sc1
    buffer_load_dwordx4 v[24:27], v1, s[4:7], s65 offen offset:0 sc1
    buffer_load_dwordx4 v[28:31], v1, s[4:7], s65 offen offset:1024 sc1
    buffer_load_dwordx4 v[32:35], v1, s[4:7], s65 offen offset:2048 sc1
    buffer_load_dwordx4 v[36:39], v1, s[4:7], s65 offen offset:3072 sc1
    s_add_u32 s57, s57, 1
    s_waitcnt vmcnt(0)
    v_max3_u32 v52, v8, v9, v10
    v_max3_u32 v52, v52, v11, v12
    v_max3_u32 v52, v52, v13, v14
    v_max3_u32 v52, v52, v15, v16
    v_max3_u32 v52, v52, v17, v18
    v_max3_u32 v52, v52, v19, v20
    v_max3_u32 v52, v52, v21, v22
    v_max3_u32 v52, v52, v23, v24
    v_max3_u32 v52, v52, v25, v26
    v_max3_u32 v52, v52, v27, v28
    v_max3_u32 v52, v52, v29, v30
    v_max3_u32 v52, v52, v31, v32
    v_max3_u32 v52, v52, v33, v34
    v_max3_u32 v52, v52, v35, v36
    v_max3_u32 v52, v52, v37, v38
    v_max3_u32 v52, v52, v39, v40
    v_max3_u32 v52, v52, v41, v42
    v_max_u32 v52, v52, v43
    v_cmp_eq_u32 vcc, -1, v52
    s_cmp_gt_u32 s57, 400000
    s_cbranch_scc1 L_rd122
    s_cbranch_vccnz L_rt121
    s_branch L_kva66
L_rd122:
    s_nop 3
    s_branch L_back68
L_ool69:
    s_cmp_eq_u32 s49, 0
    s_cselect_b32 s57, 400000, 0
L_pl123:
    buffer_load_dword v80, v210, s[4:7], s71 offen sc1
    s_sub_u32 s57, s57, 1
    s_waitcnt vmcnt(0)
    v_cmp_ne_u32 vcc, s47, v80
    s_cbranch_scc1 L_ps125
    s_cbranch_vccnz L_pl123
L_pe126:
    s_nop 3
    s_branch L_back70
L_ool71:
    s_waitcnt vmcnt(0)
    buffer_wbl2 sc1
    s_waitcnt vmcnt(0)
    s_add_u32 s61, s69, 65536
    buffer_store_dword v99, v2, s[4:7], s61 offen sc1
    s_waitcnt vmcnt(0)
    s_nop 3
    s_branch L_back72
L_ps75:
    s_cmp_lg_u32 s49, 0
    s_cbranch_scc1 L_pk129
    s_branch L_pe76
L_pk129:
    s_mov_b32 s57, 0
    s_add_u32 s61, s71, 65536
L_pt128:
    buffer_load_dword v42, v40, s[4:7], s71 offen sc1
    buffer_load_dword v44, v40, s[4:7], s61 offen sc1
    s_add_u32 s57, s57, 1
    s_waitcnt vmcnt(0)
    v_xor_b32 v42, s47, v42
    v_xor_b32 v44, s48, v44
    v_min_u32 v42, v42, v44
    v_cmp_ne_u32 vcc, 0, v42
    s_cmp_gt_u32 s57, 400000
    s_cbranch_scc1 L_pd74
    s_cbranch_vccnz L_pt128
L_pd74:
    buffer_inv sc1
    s_waitcnt vmcnt(0)
    s_nop 3
    s_branch L_pe76
L_ool78:
    s_waitcnt vmcnt(0)
    s_add_u32 s61, s68, 65536
    buffer_store_dword v99, v87, s[4:7], s61 offen sc1
    s_waitcnt vmcnt(0)
    s_nop 3
    s_branch L_back79
L_ool80:
    s_cmp_eq_u32 s49, 0
    s_cselect_b32 s57, 400000, 0
L_pl130:
    buffer_load_dword v42, v45, s[4:7], s72 offen sc1
    s_sub_u32 s57, s57, 1
    s_waitcnt vmcnt(0)
    v_cmp_ne_u32 vcc, s47, v42
    s_cbranch_scc1 L_ps132
    s_cbranch_vccnz L_pl130
L_pe133:
    s_nop 3
    s_branch L_back81
L_ps93:
    s_cmp_lg_u32 s49, 0
    s_cbranch_scc1 L_pk136
    s_branch L_pe94
L_pk136:
    s_mov_b32 s57, 0
    s_add_u32 s61, s68, 65536
L_pt135:
    buffer_load_dword v48, v46, s[4:7], s68 offen sc1
    buffer_load_dword v50, v46, s[4:7], s61 offen sc1
    s_add_u32 s57, s57, 1
    s_waitcnt vmcnt(0)
    v_xor_b32 v48, s47, v48
    v_xor_b32 v50, s48, v50
    v_min_u32 v48, v48, v50
    v_cmp_ne_u32 vcc, 0, v48
    s_cmp_gt_u32 s57, 400000
    s_cbranch_scc1 L_pd92
    s_cbranch_vccnz L_pt135
L_pd92:
    buffer_inv sc1
    s_waitcnt vmcnt(0)
    s_nop 3
    s_branch L_pe94
L_ps108:
    s_cmp_lg_u32 s49, 0
    s_cbranch_scc1 L_pk138
    s_branch L_pe109
L_pk138:
    s_mov_b32 s57, 0
    s_add_u32 s61, s71, 65536
L_pt137:
    buffer_load_dword v80, v210, s[4:7], s71 offen sc1
    buffer_load_dword v82, v210, s[4:7], s61 offen sc1
    s_add_u32 s57, s57, 1
    s_waitcnt vmcnt(0)
    v_xor_b32 v80, s47, v80
    v_xor_b32 v82, s48, v82
    v_min_u32 v80, v80, v82
    v_cmp_ne_u32 vcc, 0, v80
    s_cmp_gt_u32 s57, 400000
    s_cbranch_scc1 L_pd107
    s_cbranch_vccnz L_pt137
L_pd107:
    buffer_inv sc1
    s_waitcnt vmcnt(0)
    s_nop 3
    s_branch L_pe109
L_ps125:
    s_cmp_lg_u32 s49, 0
    s_cbranch_scc1 L_pk140
    s_branch L_pe126
L_pk140:
    s_mov_b32 s57, 0
    s_add_u32 s61, s71, 65536
L_pt139:
    buffer_load_dword v80, v210, s[4:7], s71 offen sc1
    buffer_load_dword v82, v210, s[4:7], s61 offen sc1
    s_add_u32 s57, s57, 1
    s_waitcnt vmcnt(0)
    v_xor_b32 v80, s47, v80
    v_xor_b32 v82, s48, v82
    v_min_u32 v80, v80, v82
    v_cmp_ne_u32 vcc, 0, v80
    s_cmp_gt_u32 s57, 400000
    s_cbranch_scc1 L_pd124
    s_cbranch_vccnz L_pt139
L_pd124:
    buffer_inv sc1
    s_waitcnt vmcnt(0)
    s_nop 3
    s_branch L_pe126
L_ps132:
    s_cmp_lg_u32 s49, 0
    s_cbranch_scc1 L_pk142
    s_branch L_pe133
L_pk142:
    s_mov_b32 s57, 0
    s_add_u32 s61, s72, 65536
L_pt141:
    buffer_load_dword v42, v45, s[4:7], s72 offen sc1
    buffer_load_dword v44, v45, s[4:7], s61 offen sc1
    s_add_u32 s57, s57, 1
    s_waitcnt vmcnt(0)
    v_xor_b32 v42, s47, v42
    v_xor_b32 v44, s48, v44
    v_min_u32 v42, v42, v44
    v_cmp_ne_u32 vcc, 0, v42
    s_cmp_gt_u32 s57, 400000
    s_cbranch_scc1 L_pd131
    s_cbranch_vccnz L_pt141
L_pd131:
    buffer_inv sc1
    s_waitcnt vmcnt(0)
    s_nop 3
    s_branch L_pe133
.section .rodata,"a"
.p2align 6
.amdhsa_kernel interleave_layers__ssm_conv_h3__linear_attn_block__prompt_kernel
  .amdhsa_next_free_vgpr 512
  .amdhsa_next_free_sgpr 102
  .amdhsa_accum_offset 256
  .amdhsa_group_segment_fixed_size 0
  .amdhsa_kernarg_size 96
  .amdhsa_user_sgpr_count 2
  .amdhsa_user_sgpr_kernarg_segment_ptr 1
  .amdhsa_system_sgpr_workgroup_id_x 1
.end_amdhsa_kernel
```
